```python
import torch

def _softmax(x, axis=-1):
    return torch.softmax(x, dim=axis)
def _gelu(x):
    return torch.nn.functional.gelu(x, approximate="tanh")
def _silu(x):
    return torch.nn.functional.silu(x)
def _sigmoid(x):
    return torch.sigmoid(x)
def _layernorm(x, axis=-1, eps=1e-5):
    m = x.mean(dim=axis, keepdim=True)
    v = x.var(dim=axis, keepdim=True, unbiased=False)
    return (x - m) / torch.sqrt(v + eps)
def _scatter_add(tgt, idx, src, axis=0):
    return tgt.clone().index_add_(axis, idx, src)
def _segment_sum(src, seg, n):
    out = torch.zeros((n,) + src.shape[1:], dtype=src.dtype)
    return out.index_add_(0, seg, src)
def _pad(x, pw):
    flat = tuple(v for pair in reversed(pw) for v in pair)
    return torch.nn.functional.pad(x, flat)

kernel_name = 'sequential_preLN__mha_block_cached__geglu_ffn__decode'

def setup_inputs():

    _w = (lambda a: (lambda t: t.to(torch.bfloat16) if t.is_floating_point() else t)(torch.as_tensor(a)))
    def _A_setup():
        B, Sq, D = 1, 1, 512
        H, Sk, Dh = 32, 4096, 128
        return {
            "x": _w((lambda *s: torch.randn(*s, dtype=torch.bfloat16) * 0.05)(B, Sq, D)),
            "k_cache": _w((lambda *s: torch.randn(*s, dtype=torch.bfloat16) * 3.2)(B, H, Sk, Dh)),
            "v_cache": _w((lambda *s: torch.randn(*s, dtype=torch.bfloat16) * 0.4)(B, H, Sk, Dh)),
            "wq": _w((lambda *s: torch.randn(*s, dtype=torch.bfloat16) * 3.2)(D, H * Dh) * (D ** -0.5)),
            "wo": _w((lambda *s: torch.randn(*s, dtype=torch.bfloat16) * 0.4)(H * Dh, D) * ((H * Dh) ** -0.5)),
        }
    _A_in = _A_setup()

    def _B_setup():
        B, S, D, F = 1, 1, 512, 1376
        return {
            "x": _w((lambda *s: torch.randn(*s, dtype=torch.bfloat16) * 0.05)(B, S, D)),
            "w_gate": _w((lambda *s: torch.randn(*s, dtype=torch.bfloat16) * 0.05)(D, F)),
            "w_up": _w((lambda *s: torch.randn(*s, dtype=torch.bfloat16) * 0.05)(D, F)),
            "w_down": _w((lambda *s: torch.randn(*s, dtype=torch.bfloat16) * 0.05)(F, D)),
        }
    _B_in = _B_setup()

    return {
        "A_x": _A_in["x"],
        "A_k_cache": _A_in["k_cache"],
        "A_v_cache": _A_in["v_cache"],
        "A_wq": _A_in["wq"],
        "A_wo": _A_in["wo"],
        "B_x": _B_in["x"],
        "B_w_gate": _B_in["w_gate"],
        "B_w_up": _B_in["w_up"],
        "B_w_down": _B_in["w_down"],
    }

def reference(A_x, A_k_cache, A_v_cache, A_wq, A_wo, B_x, B_w_gate, B_w_up, B_w_down):
    def _A_ref(x, k_cache, v_cache, wq, wo):
        B, Sq, D = x.shape
        H, Dh = 32, 128
        q = (lambda x, *d: x.permute(*d))((x @ wq).reshape(B, Sq, H, Dh), 0, 2, 1, 3)
        scores = torch.einsum("bhqd,bhkd->bhqk", q, k_cache) * (Dh ** -0.5)
        p = _softmax(scores, axis=-1)
        o = torch.einsum("bhqk,bhkd->bhqd", p, v_cache)
        return (lambda x, *d: x.permute(*d))(o, 0, 2, 1, 3).reshape(B, Sq, H * Dh) @ wo

    def _B_ref(x, w_gate, w_up, w_down):
        return (_gelu(x @ w_gate) * (x @ w_up)) @ w_down

    x = A_x
    h = x + _A_ref(_layernorm(x, axis=-1), A_k_cache, A_v_cache, A_wq, A_wo)
    h2 = h + _B_ref(_layernorm(h, axis=-1), B_w_gate, B_w_up, B_w_down)
    return h2
```

```asm
; @launch grid=(256,1,1) block=(768,1,1) lds=40960
.amdgcn_target "amdgcn-amd-amdhsa--gfx950"
.text
.globl sequential_preLN__mha_block_cached__geglu_ffn__decode_kernel
.p2align 8
.type sequential_preLN__mha_block_cached__geglu_ffn__decode_kernel,@function
sequential_preLN__mha_block_cached__geglu_ffn__decode_kernel:
    s_cmp_ge_u32 s2, 256
    s_cbranch_scc1 L_end
    s_load_dwordx16 s[4:19], s[0:1], 0
    s_load_dwordx8 s[20:27], s[0:1], 64
    v_lshrrev_b32 v1, 6, v0
    v_and_b32 v0, 63, v0
    s_and_b32 s28, s2, 7
    v_readfirstlane_b32 s3, v1
    s_lshr_b32 s29, s2, 3
    s_lshr_b32 s30, s29, 3
    s_lshl_b32 s52, s28, 2
    s_add_u32 s30, s30, s52
    s_and_b32 s31, s29, 7
    v_lshlrev_b32 v2, 4, v0
    s_and_b32 s61, s3, 3
    s_mov_b32 s35, 0x20000
    s_cmp_lt_u32 s3, 4
    s_cbranch_scc0 L_KV
    s_setprio 3
    v_lshrrev_b32 v3, 4, v0
    v_and_b32 v4, 15, v0
    v_and_b32 v5, 3, v0
    v_lshl_add_u32 v5, v5, 2, v3
    s_lshl_b32 s52, s31, 2
    s_add_u32 s52, s52, s61
    s_lshl_b32 s53, s52, 4
    v_add_u32 v5, s53, v5
    v_lshlrev_b32 v5, 1, v5
    v_lshlrev_b32 v6, 13, v3
    v_lshl_add_u32 v6, v4, 4, v6
    s_lshl_b32 s52, s52, 17
    s_lshl_b32 s53, s30, 8
    s_add_u32 s52, s52, s53
    s_mov_b32 s34, 0x400000
    s_mov_b32 s42, 1024
    s_mov_b32 s43, 0x20000
    s_waitcnt lgkmcnt(0)
    s_load_dword s44, s[26:27], 0
    s_mov_b32 s40, s4
    s_and_b32 s41, s5, 0xffff
    s_mov_b32 s32, s10
    s_and_b32 s33, s11, 0xffff
    buffer_load_dwordx4 v[8:11], v2, s[40:43], 0 offen
    buffer_load_ushort v12, v5, s[40:43], 0 offen
    buffer_load_dwordx4 v[16:19], v6, s[32:35], s52 offen nt
    s_add_u32 s52, s52, 0x8000
    buffer_load_dwordx4 v[20:23], v6, s[32:35], s52 offen nt
    s_add_u32 s52, s52, 0x8000
    buffer_load_dwordx4 v[24:27], v6, s[32:35], s52 offen nt
    s_add_u32 s52, s52, 0x8000
    buffer_load_dwordx4 v[28:31], v6, s[32:35], s52 offen nt
    s_barrier
    s_branch L_H
L_KV:
    s_cmp_eq_u32 s3, 11
    s_cbranch_scc0 L_noclr
    v_mov_b32 v4, 0
    v_mov_b32 v5, 0
    v_mov_b32 v6, 0
    v_mov_b32 v7, 0
    s_mov_b64 exec, 1
    ds_write_b128 v4, v[4:7] offset:256
    ds_write_b128 v4, v[4:7] offset:6272
    s_mov_b64 exec, -1
L_noclr:
    s_lshl_b32 s54, s30, 20
    s_lshl_b32 s53, s31, 17
    s_add_u32 s54, s54, s53
    s_lshl_b32 s52, s61, 10
    s_mov_b32 s34, 0x20000
    s_waitcnt lgkmcnt(0)
    s_cmp_lt_u32 s3, 8
    s_cbranch_scc1 L_K
    s_barrier
    s_branch L_V

L_K:
    s_setprio 2
    s_add_u32 s32, s6, s54
    s_addc_u32 s33, s7, 0
    s_and_b32 s33, s33, 0xffff
    buffer_load_dwordx4 v[40:43], v2, s[32:35], s52 offen nt
    s_add_u32 s52, s52, 4096
    buffer_load_dwordx4 v[44:47], v2, s[32:35], s52 offen nt
    s_add_u32 s52, s52, 4096
    buffer_load_dwordx4 v[48:51], v2, s[32:35], s52 offen nt
    s_barrier
    s_add_u32 s52, s52, 4096
    buffer_load_dwordx4 v[52:55], v2, s[32:35], s52 offen nt
    s_add_u32 s52, s52, 4096
    buffer_load_dwordx4 v[56:59], v2, s[32:35], s52 offen nt
    s_add_u32 s52, s52, 4096
    buffer_load_dwordx4 v[60:63], v2, s[32:35], s52 offen nt
    s_add_u32 s52, s52, 4096
    buffer_load_dwordx4 v[64:67], v2, s[32:35], s52 offen nt
    s_add_u32 s52, s52, 4096
    buffer_load_dwordx4 v[68:71], v2, s[32:35], s52 offen nt
    s_add_u32 s52, s52, 4096
    buffer_load_dwordx4 v[72:75], v2, s[32:35], s52 offen nt
    s_add_u32 s52, s52, 4096
    buffer_load_dwordx4 v[76:79], v2, s[32:35], s52 offen nt
    s_add_u32 s52, s52, 4096
    buffer_load_dwordx4 v[80:83], v2, s[32:35], s52 offen nt
    s_add_u32 s52, s52, 4096
    buffer_load_dwordx4 v[84:87], v2, s[32:35], s52 offen nt
    s_add_u32 s52, s52, 4096
    buffer_load_dwordx4 v[88:91], v2, s[32:35], s52 offen nt
    s_add_u32 s52, s52, 4096
    buffer_load_dwordx4 v[92:95], v2, s[32:35], s52 offen nt
    s_add_u32 s52, s52, 4096
    buffer_load_dwordx4 v[96:99], v2, s[32:35], s52 offen nt
    s_add_u32 s52, s52, 4096
    buffer_load_dwordx4 v[100:103], v2, s[32:35], s52 offen nt
    s_add_u32 s52, s52, 4096
    buffer_load_dwordx4 v[104:107], v2, s[32:35], s52 offen nt
    s_add_u32 s52, s52, 4096
    buffer_load_dwordx4 v[108:111], v2, s[32:35], s52 offen nt
    s_add_u32 s52, s52, 4096
    buffer_load_dwordx4 v[112:115], v2, s[32:35], s52 offen nt
    s_add_u32 s52, s52, 4096
    buffer_load_dwordx4 v[116:119], v2, s[32:35], s52 offen nt
    s_add_u32 s52, s52, 4096
    buffer_load_dwordx4 v[120:123], v2, s[32:35], s52 offen nt
    s_add_u32 s52, s52, 4096
    buffer_load_dwordx4 v[124:127], v2, s[32:35], s52 offen nt
    s_add_u32 s52, s52, 4096
    buffer_load_dwordx4 v[128:131], v2, s[32:35], s52 offen nt
    s_add_u32 s52, s52, 4096
    buffer_load_dwordx4 v[132:135], v2, s[32:35], s52 offen nt
    s_add_u32 s52, s52, 4096
    buffer_load_dwordx4 v[136:139], v2, s[32:35], s52 offen nt
    s_add_u32 s52, s52, 4096
    buffer_load_dwordx4 v[140:143], v2, s[32:35], s52 offen nt
    s_add_u32 s52, s52, 4096
    buffer_load_dwordx4 v[144:147], v2, s[32:35], s52 offen nt
    s_add_u32 s52, s52, 4096
    buffer_load_dwordx4 v[148:151], v2, s[32:35], s52 offen nt
    s_add_u32 s52, s52, 4096
    buffer_load_dwordx4 v[152:155], v2, s[32:35], s52 offen nt
    s_add_u32 s52, s52, 4096
    buffer_load_dwordx4 v[156:159], v2, s[32:35], s52 offen nt
    s_add_u32 s52, s52, 4096
    buffer_load_dwordx4 v[160:163], v2, s[32:35], s52 offen nt
    s_add_u32 s52, s52, 4096
    buffer_load_dwordx4 v[164:167], v2, s[32:35], s52 offen nt
    s_load_dword s44, s[26:27], 0
    s_mov_b32 s36, s26
    s_and_b32 s37, s27, 0xffff
    s_mov_b32 s38, 0x200000
    s_mov_b32 s39, 0x20000
    s_mov_b32 s54, 0xcccccccc
    s_mov_b32 s55, 0xcccccccc
    s_mov_b32 s56, 0xaaaaaaaa
    s_mov_b32 s57, 0xaaaaaaaa
    v_and_b32 v8, 15, v0
    v_lshlrev_b32 v8, 4, v8
    v_mov_b32 v9, 0
    s_waitcnt lgkmcnt(0)
    s_add_u32 s44, s44, 0x9e3779b1
    s_and_b32 s68, s44, 0xff
    s_bfe_u32 s45, s44, 0x80008
    s_bfe_u32 s46, s44, 0x80010
    s_lshr_b32 s47, s44, 24
    s_mov_b32 s60, 0
L_K_wait:
    ds_read_b32 v3, v9 offset:256
    s_waitcnt lgkmcnt(0)
    v_readfirstlane_b32 s52, v3
    s_cmp_eq_u32 s52, 1
    s_cbranch_scc1 L_K_wait_ok
    s_sleep 1
    s_add_u32 s60, s60, 1
    s_cmp_lt_u32 s60, 1000000
    s_cbranch_scc1 L_K_wait
L_K_wait_ok:
    ds_read_b128 v[4:7], v8 offset:0
    s_waitcnt lgkmcnt(0)
    s_waitcnt vmcnt(31)
    v_dot2_f32_bf16 v40, v40, v4, 0
    v_dot2_f32_bf16 v40, v41, v5, v40
    v_dot2_f32_bf16 v40, v42, v6, v40
    v_dot2_f32_bf16 v40, v43, v7, v40
    s_waitcnt vmcnt(30)
    v_dot2_f32_bf16 v44, v44, v4, 0
    v_dot2_f32_bf16 v44, v45, v5, v44
    v_dot2_f32_bf16 v44, v46, v6, v44
    v_dot2_f32_bf16 v44, v47, v7, v44
    s_waitcnt vmcnt(29)
    v_dot2_f32_bf16 v48, v48, v4, 0
    v_dot2_f32_bf16 v48, v49, v5, v48
    v_dot2_f32_bf16 v48, v50, v6, v48
    v_dot2_f32_bf16 v48, v51, v7, v48
    s_waitcnt vmcnt(28)
    v_dot2_f32_bf16 v52, v52, v4, 0
    v_dot2_f32_bf16 v52, v53, v5, v52
    v_dot2_f32_bf16 v52, v54, v6, v52
    v_dot2_f32_bf16 v52, v55, v7, v52
    s_waitcnt vmcnt(27)
    v_dot2_f32_bf16 v56, v56, v4, 0
    v_dot2_f32_bf16 v56, v57, v5, v56
    v_dot2_f32_bf16 v56, v58, v6, v56
    v_dot2_f32_bf16 v56, v59, v7, v56
    s_waitcnt vmcnt(26)
    v_dot2_f32_bf16 v60, v60, v4, 0
    v_dot2_f32_bf16 v60, v61, v5, v60
    v_dot2_f32_bf16 v60, v62, v6, v60
    v_dot2_f32_bf16 v60, v63, v7, v60
    s_waitcnt vmcnt(25)
    v_dot2_f32_bf16 v64, v64, v4, 0
    v_dot2_f32_bf16 v64, v65, v5, v64
    v_dot2_f32_bf16 v64, v66, v6, v64
    v_dot2_f32_bf16 v64, v67, v7, v64
    s_waitcnt vmcnt(24)
    v_dot2_f32_bf16 v68, v68, v4, 0
    v_dot2_f32_bf16 v68, v69, v5, v68
    v_dot2_f32_bf16 v68, v70, v6, v68
    v_dot2_f32_bf16 v68, v71, v7, v68
    s_waitcnt vmcnt(23)
    v_dot2_f32_bf16 v72, v72, v4, 0
    v_dot2_f32_bf16 v72, v73, v5, v72
    v_dot2_f32_bf16 v72, v74, v6, v72
    v_dot2_f32_bf16 v72, v75, v7, v72
    s_waitcnt vmcnt(22)
    v_dot2_f32_bf16 v76, v76, v4, 0
    v_dot2_f32_bf16 v76, v77, v5, v76
    v_dot2_f32_bf16 v76, v78, v6, v76
    v_dot2_f32_bf16 v76, v79, v7, v76
    s_waitcnt vmcnt(21)
    v_dot2_f32_bf16 v80, v80, v4, 0
    v_dot2_f32_bf16 v80, v81, v5, v80
    v_dot2_f32_bf16 v80, v82, v6, v80
    v_dot2_f32_bf16 v80, v83, v7, v80
    s_waitcnt vmcnt(20)
    v_dot2_f32_bf16 v84, v84, v4, 0
    v_dot2_f32_bf16 v84, v85, v5, v84
    v_dot2_f32_bf16 v84, v86, v6, v84
    v_dot2_f32_bf16 v84, v87, v7, v84
    s_waitcnt vmcnt(19)
    v_dot2_f32_bf16 v88, v88, v4, 0
    v_dot2_f32_bf16 v88, v89, v5, v88
    v_dot2_f32_bf16 v88, v90, v6, v88
    v_dot2_f32_bf16 v88, v91, v7, v88
    s_waitcnt vmcnt(18)
    v_dot2_f32_bf16 v92, v92, v4, 0
    v_dot2_f32_bf16 v92, v93, v5, v92
    v_dot2_f32_bf16 v92, v94, v6, v92
    v_dot2_f32_bf16 v92, v95, v7, v92
    s_waitcnt vmcnt(17)
    v_dot2_f32_bf16 v96, v96, v4, 0
    v_dot2_f32_bf16 v96, v97, v5, v96
    v_dot2_f32_bf16 v96, v98, v6, v96
    v_dot2_f32_bf16 v96, v99, v7, v96
    s_waitcnt vmcnt(16)
    v_dot2_f32_bf16 v100, v100, v4, 0
    v_dot2_f32_bf16 v100, v101, v5, v100
    v_dot2_f32_bf16 v100, v102, v6, v100
    v_dot2_f32_bf16 v100, v103, v7, v100
    v_add_f32_dpp v41, v40, v40 row_ror:8 row_mask:0xf bank_mask:0x3
    v_add_f32_dpp v45, v44, v44 row_ror:8 row_mask:0xf bank_mask:0x3
    v_add_f32_dpp v49, v48, v48 row_ror:8 row_mask:0xf bank_mask:0x3
    v_add_f32_dpp v53, v52, v52 row_ror:8 row_mask:0xf bank_mask:0x3
    v_add_f32_dpp v57, v56, v56 row_ror:8 row_mask:0xf bank_mask:0x3
    v_add_f32_dpp v61, v60, v60 row_ror:8 row_mask:0xf bank_mask:0x3
    v_add_f32_dpp v65, v64, v64 row_ror:8 row_mask:0xf bank_mask:0x3
    v_add_f32_dpp v69, v68, v68 row_ror:8 row_mask:0xf bank_mask:0x3
    v_add_f32_dpp v41, v72, v72 row_ror:8 row_mask:0xf bank_mask:0xc
    v_add_f32_dpp v45, v76, v76 row_ror:8 row_mask:0xf bank_mask:0xc
    v_add_f32_dpp v49, v80, v80 row_ror:8 row_mask:0xf bank_mask:0xc
    v_add_f32_dpp v53, v84, v84 row_ror:8 row_mask:0xf bank_mask:0xc
    v_add_f32_dpp v57, v88, v88 row_ror:8 row_mask:0xf bank_mask:0xc
    v_add_f32_dpp v61, v92, v92 row_ror:8 row_mask:0xf bank_mask:0xc
    v_add_f32_dpp v65, v96, v96 row_ror:8 row_mask:0xf bank_mask:0xc
    v_add_f32_dpp v69, v100, v100 row_ror:8 row_mask:0xf bank_mask:0xc
    v_add_f32_dpp v42, v41, v41 row_shl:4 row_mask:0xf bank_mask:0x5
    v_add_f32_dpp v46, v45, v45 row_shl:4 row_mask:0xf bank_mask:0x5
    v_add_f32_dpp v50, v49, v49 row_shl:4 row_mask:0xf bank_mask:0x5
    v_add_f32_dpp v54, v53, v53 row_shl:4 row_mask:0xf bank_mask:0x5
    v_add_f32_dpp v42, v57, v57 row_shr:4 row_mask:0xf bank_mask:0xa
    v_add_f32_dpp v46, v61, v61 row_shr:4 row_mask:0xf bank_mask:0xa
    v_add_f32_dpp v50, v65, v65 row_shr:4 row_mask:0xf bank_mask:0xa
    v_add_f32_dpp v54, v69, v69 row_shr:4 row_mask:0xf bank_mask:0xa
    v_add_f32_dpp v43, v42, v42 quad_perm:[2,3,0,1] row_mask:0xf bank_mask:0xf
    v_add_f32_dpp v47, v46, v46 quad_perm:[2,3,0,1] row_mask:0xf bank_mask:0xf
    v_add_f32_dpp v51, v50, v50 quad_perm:[2,3,0,1] row_mask:0xf bank_mask:0xf
    v_add_f32_dpp v55, v54, v54 quad_perm:[2,3,0,1] row_mask:0xf bank_mask:0xf
    v_cndmask_b32 v59, v43, v51, s[54:55]
    v_cndmask_b32 v63, v47, v55, s[54:55]
    s_nop 0
    v_add_f32_dpp v67, v59, v59 quad_perm:[1,0,3,2] row_mask:0xf bank_mask:0xf
    v_add_f32_dpp v71, v63, v63 quad_perm:[1,0,3,2] row_mask:0xf bank_mask:0xf
    v_cndmask_b32 v10, v67, v71, s[56:57]
    s_waitcnt vmcnt(15)
    v_dot2_f32_bf16 v104, v104, v4, 0
    v_dot2_f32_bf16 v104, v105, v5, v104
    v_dot2_f32_bf16 v104, v106, v6, v104
    v_dot2_f32_bf16 v104, v107, v7, v104
    s_waitcnt vmcnt(14)
    v_dot2_f32_bf16 v108, v108, v4, 0
    v_dot2_f32_bf16 v108, v109, v5, v108
    v_dot2_f32_bf16 v108, v110, v6, v108
    v_dot2_f32_bf16 v108, v111, v7, v108
    s_waitcnt vmcnt(13)
    v_dot2_f32_bf16 v112, v112, v4, 0
    v_dot2_f32_bf16 v112, v113, v5, v112
    v_dot2_f32_bf16 v112, v114, v6, v112
    v_dot2_f32_bf16 v112, v115, v7, v112
    s_waitcnt vmcnt(12)
    v_dot2_f32_bf16 v116, v116, v4, 0
    v_dot2_f32_bf16 v116, v117, v5, v116
    v_dot2_f32_bf16 v116, v118, v6, v116
    v_dot2_f32_bf16 v116, v119, v7, v116
    s_waitcnt vmcnt(11)
    v_dot2_f32_bf16 v120, v120, v4, 0
    v_dot2_f32_bf16 v120, v121, v5, v120
    v_dot2_f32_bf16 v120, v122, v6, v120
    v_dot2_f32_bf16 v120, v123, v7, v120
    s_waitcnt vmcnt(10)
    v_dot2_f32_bf16 v124, v124, v4, 0
    v_dot2_f32_bf16 v124, v125, v5, v124
    v_dot2_f32_bf16 v124, v126, v6, v124
    v_dot2_f32_bf16 v124, v127, v7, v124
    s_waitcnt vmcnt(9)
    v_dot2_f32_bf16 v128, v128, v4, 0
    v_dot2_f32_bf16 v128, v129, v5, v128
    v_dot2_f32_bf16 v128, v130, v6, v128
    v_dot2_f32_bf16 v128, v131, v7, v128
    s_waitcnt vmcnt(8)
    v_dot2_f32_bf16 v132, v132, v4, 0
    v_dot2_f32_bf16 v132, v133, v5, v132
    v_dot2_f32_bf16 v132, v134, v6, v132
    v_dot2_f32_bf16 v132, v135, v7, v132
    s_waitcnt vmcnt(7)
    v_dot2_f32_bf16 v136, v136, v4, 0
    v_dot2_f32_bf16 v136, v137, v5, v136
    v_dot2_f32_bf16 v136, v138, v6, v136
    v_dot2_f32_bf16 v136, v139, v7, v136
    s_waitcnt vmcnt(6)
    v_dot2_f32_bf16 v140, v140, v4, 0
    v_dot2_f32_bf16 v140, v141, v5, v140
    v_dot2_f32_bf16 v140, v142, v6, v140
    v_dot2_f32_bf16 v140, v143, v7, v140
    s_waitcnt vmcnt(5)
    v_dot2_f32_bf16 v144, v144, v4, 0
    v_dot2_f32_bf16 v144, v145, v5, v144
    v_dot2_f32_bf16 v144, v146, v6, v144
    v_dot2_f32_bf16 v144, v147, v7, v144
    s_waitcnt vmcnt(4)
    v_dot2_f32_bf16 v148, v148, v4, 0
    v_dot2_f32_bf16 v148, v149, v5, v148
    v_dot2_f32_bf16 v148, v150, v6, v148
    v_dot2_f32_bf16 v148, v151, v7, v148
    s_waitcnt vmcnt(3)
    v_dot2_f32_bf16 v152, v152, v4, 0
    v_dot2_f32_bf16 v152, v153, v5, v152
    v_dot2_f32_bf16 v152, v154, v6, v152
    v_dot2_f32_bf16 v152, v155, v7, v152
    s_waitcnt vmcnt(2)
    v_dot2_f32_bf16 v156, v156, v4, 0
    v_dot2_f32_bf16 v156, v157, v5, v156
    v_dot2_f32_bf16 v156, v158, v6, v156
    v_dot2_f32_bf16 v156, v159, v7, v156
    s_waitcnt vmcnt(1)
    v_dot2_f32_bf16 v160, v160, v4, 0
    v_dot2_f32_bf16 v160, v161, v5, v160
    v_dot2_f32_bf16 v160, v162, v6, v160
    v_dot2_f32_bf16 v160, v163, v7, v160
    s_waitcnt vmcnt(0)
    v_dot2_f32_bf16 v164, v164, v4, 0
    v_dot2_f32_bf16 v164, v165, v5, v164
    v_dot2_f32_bf16 v164, v166, v6, v164
    v_dot2_f32_bf16 v164, v167, v7, v164
    v_add_f32_dpp v105, v104, v104 row_ror:8 row_mask:0xf bank_mask:0x3
    v_add_f32_dpp v109, v108, v108 row_ror:8 row_mask:0xf bank_mask:0x3
    v_add_f32_dpp v113, v112, v112 row_ror:8 row_mask:0xf bank_mask:0x3
    v_add_f32_dpp v117, v116, v116 row_ror:8 row_mask:0xf bank_mask:0x3
    v_add_f32_dpp v121, v120, v120 row_ror:8 row_mask:0xf bank_mask:0x3
    v_add_f32_dpp v125, v124, v124 row_ror:8 row_mask:0xf bank_mask:0x3
    v_add_f32_dpp v129, v128, v128 row_ror:8 row_mask:0xf bank_mask:0x3
    v_add_f32_dpp v133, v132, v132 row_ror:8 row_mask:0xf bank_mask:0x3
    v_add_f32_dpp v105, v136, v136 row_ror:8 row_mask:0xf bank_mask:0xc
    v_add_f32_dpp v109, v140, v140 row_ror:8 row_mask:0xf bank_mask:0xc
    v_add_f32_dpp v113, v144, v144 row_ror:8 row_mask:0xf bank_mask:0xc
    v_add_f32_dpp v117, v148, v148 row_ror:8 row_mask:0xf bank_mask:0xc
    v_add_f32_dpp v121, v152, v152 row_ror:8 row_mask:0xf bank_mask:0xc
    v_add_f32_dpp v125, v156, v156 row_ror:8 row_mask:0xf bank_mask:0xc
    v_add_f32_dpp v129, v160, v160 row_ror:8 row_mask:0xf bank_mask:0xc
    v_add_f32_dpp v133, v164, v164 row_ror:8 row_mask:0xf bank_mask:0xc
    v_add_f32_dpp v106, v105, v105 row_shl:4 row_mask:0xf bank_mask:0x5
    v_add_f32_dpp v110, v109, v109 row_shl:4 row_mask:0xf bank_mask:0x5
    v_add_f32_dpp v114, v113, v113 row_shl:4 row_mask:0xf bank_mask:0x5
    v_add_f32_dpp v118, v117, v117 row_shl:4 row_mask:0xf bank_mask:0x5
    v_add_f32_dpp v106, v121, v121 row_shr:4 row_mask:0xf bank_mask:0xa
    v_add_f32_dpp v110, v125, v125 row_shr:4 row_mask:0xf bank_mask:0xa
    v_add_f32_dpp v114, v129, v129 row_shr:4 row_mask:0xf bank_mask:0xa
    v_add_f32_dpp v118, v133, v133 row_shr:4 row_mask:0xf bank_mask:0xa
    v_add_f32_dpp v107, v106, v106 quad_perm:[2,3,0,1] row_mask:0xf bank_mask:0xf
    v_add_f32_dpp v111, v110, v110 quad_perm:[2,3,0,1] row_mask:0xf bank_mask:0xf
    v_add_f32_dpp v115, v114, v114 quad_perm:[2,3,0,1] row_mask:0xf bank_mask:0xf
    v_add_f32_dpp v119, v118, v118 quad_perm:[2,3,0,1] row_mask:0xf bank_mask:0xf
    v_cndmask_b32 v123, v107, v115, s[54:55]
    v_cndmask_b32 v127, v111, v119, s[54:55]
    s_nop 0
    v_add_f32_dpp v131, v123, v123 quad_perm:[1,0,3,2] row_mask:0xf bank_mask:0xf
    v_add_f32_dpp v135, v127, v127 quad_perm:[1,0,3,2] row_mask:0xf bank_mask:0xf
    v_cndmask_b32 v11, v131, v135, s[56:57]
    v_cvt_pk_bf16_f32 v12, v10, v11
    v_and_b32 v11, 0xffff0000, v12
    v_lshlrev_b32 v10, 16, v12
    v_mul_f32 v10, 0x3db504f3, v10
    v_mul_f32 v11, 0x3db504f3, v11
    v_cvt_pk_bf16_f32 v12, v10, v11
    v_and_b32 v11, 0xffff0000, v12
    v_lshlrev_b32 v10, 16, v12
    v_max_f32 v13, v10, v11
    s_nop 1
    v_max_f32_dpp v13, v13, v13 quad_perm:[1,0,3,2] row_mask:0xf bank_mask:0xf
    s_nop 1
    v_max_f32_dpp v13, v13, v13 quad_perm:[2,3,0,1] row_mask:0xf bank_mask:0xf
    s_nop 1
    v_max_f32_dpp v13, v13, v13 row_half_mirror row_mask:0xf bank_mask:0xf
    s_nop 1
    v_max_f32_dpp v13, v13, v13 row_mirror row_mask:0xf bank_mask:0xf
    v_mov_b32 v14, v13
    s_nop 1
    v_permlane16_swap_b32 v14, v13
    v_max_f32 v13, v13, v14
    v_mov_b32 v14, v13
    s_nop 1
    v_permlane32_swap_b32 v14, v13
    v_max_f32 v13, v13, v14
    v_sub_f32 v10, v10, v13
    v_sub_f32 v11, v11, v13
    v_mul_f32 v10, 0x3fb8aa3b, v10
    v_mul_f32 v11, 0x3fb8aa3b, v11
    v_exp_f32 v10, v10
    v_exp_f32 v11, v11
    s_lshl_b32 s53, s61, 9
    v_lshl_add_u32 v8, v0, 3, s53
    v_add_f32 v14, v10, v11
    v_cvt_pk_bf16_f32 v16, v10, v10
    v_cvt_pk_bf16_f32 v17, v11, v11
    ds_write_b64 v8, v[16:17] offset:512
    v_add_f32_dpp v14, v14, v14 quad_perm:[1,0,3,2] row_mask:0xf bank_mask:0xf
    s_nop 1
    v_add_f32_dpp v14, v14, v14 quad_perm:[2,3,0,1] row_mask:0xf bank_mask:0xf
    s_nop 1
    v_add_f32_dpp v14, v14, v14 row_half_mirror row_mask:0xf bank_mask:0xf
    s_nop 1
    v_add_f32_dpp v14, v14, v14 row_mirror row_mask:0xf bank_mask:0xf
    v_mov_b32 v15, v14
    s_nop 1
    v_permlane16_swap_b32 v15, v14
    v_add_f32 v14, v14, v15
    v_mov_b32 v15, v14
    s_nop 1
    v_permlane32_swap_b32 v15, v14
    v_add_f32 v14, v14, v15
    s_lshl_b32 s53, s61, 3
    v_mov_b32 v9, s53
    v_mov_b32 v18, v13
    v_mov_b32 v19, v14
    s_mov_b64 exec, 1
    ds_write_b64 v9, v[18:19] offset:288
    s_mov_b64 exec, -1
    s_waitcnt lgkmcnt(0)
    s_branch L_T

L_V:
    s_load_dword s44, s[26:27], 0
    s_add_u32 s32, s8, s54
    s_addc_u32 s33, s9, 0
    s_and_b32 s33, s33, 0xffff
    s_mov_b32 s36, s26
    s_and_b32 s37, s27, 0xffff
    s_mov_b32 s38, 0x200000
    s_mov_b32 s39, 0x20000
    s_mov_b32 s48, 0x7060500
    s_mov_b32 s49, 0x7060501
    s_mov_b32 s50, 0x7060502
    s_mov_b32 s51, 0x7060503
    v_bfe_u32 v3, v0, 1, 3
    v_and_b32 v4, 1, v0
    v_lshlrev_b32 v4, 4, v4
    v_mov_b32 v5, 0xffff
    v_lshlrev_b32 v4, v4, v5
    v_cmp_eq_u32 vcc, 0, v3
    s_nop 1
    v_cndmask_b32 v36, 0, v4, vcc
    v_cmp_eq_u32 vcc, 1, v3
    s_nop 1
    v_cndmask_b32 v37, 0, v4, vcc
    v_cmp_eq_u32 vcc, 2, v3
    s_nop 1
    v_cndmask_b32 v38, 0, v4, vcc
    v_cmp_eq_u32 vcc, 3, v3
    s_nop 1
    v_cndmask_b32 v39, 0, v4, vcc
    s_lshr_b32 s52, s28, 1
    s_mul_i32 s67, s52, 16
    s_mul_i32 s53, s52, 6
    s_add_u32 s53, s53, 64
    s_bitcmp1_b32 s28, 0
    s_cselect_b32 s67, s53, s67
    s_cselect_b32 s69, 6, 16
    s_sub_u32 s52, s29, 16
    s_add_u32 s62, s67, s52
    s_cmp_lt_u32 s52, s69
    s_cselect_b32 s53, 1, 0
    s_cmp_lt_u32 s62, 86
    s_cselect_b32 s63, s53, 0
    s_mov_b32 s40, s20
    s_and_b32 s41, s21, 0xffff
    s_mov_b32 s42, 0x158000
    s_mov_b32 s43, 0x20000
    s_lshl_b32 s64, s62, 14
    s_lshl_b32 s52, s61, 8
    s_add_u32 s64, s64, s52
    v_lshrrev_b32 v3, 4, v0
    v_and_b32 v4, 15, v0
    v_lshlrev_b32 v1, 10, v3
    v_lshl_add_u32 v1, v4, 4, v1
    v_lshlrev_b32 v5, 4, v3
    v_lshl_add_u32 v19, v4, 5, v5
    s_mul_i32 s59, s61, 528
    v_add_u32 v19, s59, v19
    s_lshl_b32 s53, s61, 9
    v_lshl_add_u32 v6, v0, 3, s53
    s_lshl_b32 s53, s61, 3
    v_mov_b32 v7, s53
    v_mov_b32 v3, 0
    s_lshl_b32 s66, s28, 5
    s_add_u32 s66, s66, s29
    s_mul_i32 s66, s66, 640
    s_add_u32 s66, s66, 0x50000
    s_waitcnt lgkmcnt(0)
    s_add_u32 s44, s44, 0x9e3779b1
    s_and_b32 s68, s44, 0xff
    s_bfe_u32 s45, s44, 0x80008
    s_bfe_u32 s46, s44, 0x80010
    s_lshr_b32 s47, s44, 24
    s_lshl_b32 s52, s61, 10
    buffer_load_dwordx4 v[40:43], v2, s[32:35], s52 offen nt
    s_add_u32 s52, s52, 4096
    buffer_load_dwordx4 v[44:47], v2, s[32:35], s52 offen nt
    s_add_u32 s52, s52, 4096
    buffer_load_dwordx4 v[48:51], v2, s[32:35], s52 offen nt
    s_add_u32 s52, s52, 4096
    buffer_load_dwordx4 v[52:55], v2, s[32:35], s52 offen nt
    s_add_u32 s52, s52, 4096
    buffer_load_dwordx4 v[56:59], v2, s[32:35], s52 offen nt
    s_add_u32 s52, s52, 4096
    buffer_load_dwordx4 v[60:63], v2, s[32:35], s52 offen nt
    s_add_u32 s52, s52, 4096
    buffer_load_dwordx4 v[64:67], v2, s[32:35], s52 offen nt
    s_add_u32 s52, s52, 4096
    buffer_load_dwordx4 v[68:71], v2, s[32:35], s52 offen nt
    s_add_u32 s52, s52, 4096
    buffer_load_dwordx4 v[72:75], v2, s[32:35], s52 offen nt
    s_add_u32 s52, s52, 4096
    buffer_load_dwordx4 v[76:79], v2, s[32:35], s52 offen nt
    s_add_u32 s52, s52, 4096
    buffer_load_dwordx4 v[80:83], v2, s[32:35], s52 offen nt
    s_add_u32 s52, s52, 4096
    buffer_load_dwordx4 v[84:87], v2, s[32:35], s52 offen nt
    s_add_u32 s52, s52, 4096
    buffer_load_dwordx4 v[88:91], v2, s[32:35], s52 offen nt
    s_add_u32 s52, s52, 4096
    buffer_load_dwordx4 v[92:95], v2, s[32:35], s52 offen nt
    s_add_u32 s52, s52, 4096
    buffer_load_dwordx4 v[96:99], v2, s[32:35], s52 offen nt
    s_add_u32 s52, s52, 4096
    buffer_load_dwordx4 v[100:103], v2, s[32:35], s52 offen nt
    s_add_u32 s52, s52, 4096
    buffer_load_dwordx4 v[104:107], v2, s[32:35], s52 offen nt
    s_add_u32 s52, s52, 4096
    buffer_load_dwordx4 v[108:111], v2, s[32:35], s52 offen nt
    s_add_u32 s52, s52, 4096
    buffer_load_dwordx4 v[112:115], v2, s[32:35], s52 offen nt
    s_add_u32 s52, s52, 4096
    buffer_load_dwordx4 v[116:119], v2, s[32:35], s52 offen nt
    s_add_u32 s52, s52, 4096
    buffer_load_dwordx4 v[120:123], v2, s[32:35], s52 offen nt
    s_add_u32 s52, s52, 4096
    buffer_load_dwordx4 v[124:127], v2, s[32:35], s52 offen nt
    s_add_u32 s52, s52, 4096
    buffer_load_dwordx4 v[128:131], v2, s[32:35], s52 offen nt
    s_add_u32 s52, s52, 4096
    buffer_load_dwordx4 v[132:135], v2, s[32:35], s52 offen nt
    s_add_u32 s52, s52, 4096
    buffer_load_dwordx4 v[136:139], v2, s[32:35], s52 offen nt
    s_add_u32 s52, s52, 4096
    buffer_load_dwordx4 v[140:143], v2, s[32:35], s52 offen nt
    s_add_u32 s52, s52, 4096
    buffer_load_dwordx4 v[144:147], v2, s[32:35], s52 offen nt
    s_add_u32 s52, s52, 4096
    buffer_load_dwordx4 v[148:151], v2, s[32:35], s52 offen nt
    s_add_u32 s52, s52, 4096
    buffer_load_dwordx4 v[152:155], v2, s[32:35], s52 offen nt
    s_add_u32 s52, s52, 4096
    buffer_load_dwordx4 v[156:159], v2, s[32:35], s52 offen nt
    s_add_u32 s52, s52, 4096
    buffer_load_dwordx4 v[160:163], v2, s[32:35], s52 offen nt
    s_add_u32 s52, s52, 4096
    buffer_load_dwordx4 v[164:167], v2, s[32:35], s52 offen nt
    s_barrier
    s_setprio 3
    ds_read_b64 v[4:5], v6 offset:512
    ds_read_b128 v[8:11], v3 offset:288
    ds_read_b128 v[12:15], v3 offset:304
    ds_read_b64 v[16:17], v7 offset:288
    ds_read_b32 v18, v3 offset:264
    s_waitcnt lgkmcnt(0)
    v_readfirstlane_b32 s65, v18
    v_max3_f32 v8, v8, v10, v12
    v_max_f32 v8, v8, v14
    v_sub_f32 v18, v16, v8
    v_mul_f32 v18, 0x3fb8aa3b, v18
    v_exp_f32 v18, v18
    s_cmp_eq_u32 s61, 0
    s_cselect_b64 vcc, -1, 0
    v_cndmask_b32 v20, 0, v8, vcc
    v_mul_f32 v21, v18, v17
    v_mov_b32 v22, 0
    v_mov_b32 v23, 0
    v_mov_b32 v7, s59
    v_mov_b32 v3, s44
    s_mov_b64 exec, 1
    ds_write_b128 v7, v[20:23] offset:3072
    s_mov_b64 exec, -1
    v_and_b32_dpp v28, v4, v36 row_newbcast:0 row_mask:0xf bank_mask:0xf
    v_and_b32_dpp v29, v4, v37 row_newbcast:0 row_mask:0xf bank_mask:0xf
    v_and_b32_dpp v30, v4, v38 row_newbcast:0 row_mask:0xf bank_mask:0xf
    v_and_b32_dpp v31, v4, v39 row_newbcast:0 row_mask:0xf bank_mask:0xf
    s_waitcnt vmcnt(31)
    s_nop 0
    v_mfma_f32_16x16x32_bf16 v[24:27], v[28:31], v[40:43], 0
    v_and_b32_dpp v32, v4, v36 row_newbcast:1 row_mask:0xf bank_mask:0xf
    v_and_b32_dpp v33, v4, v37 row_newbcast:1 row_mask:0xf bank_mask:0xf
    v_and_b32_dpp v34, v4, v38 row_newbcast:1 row_mask:0xf bank_mask:0xf
    v_and_b32_dpp v35, v4, v39 row_newbcast:1 row_mask:0xf bank_mask:0xf
    s_waitcnt vmcnt(30)
    s_nop 0
    v_mfma_f32_16x16x32_bf16 v[24:27], v[32:35], v[44:47], v[24:27]
    v_and_b32_dpp v28, v4, v36 row_newbcast:2 row_mask:0xf bank_mask:0xf
    v_and_b32_dpp v29, v4, v37 row_newbcast:2 row_mask:0xf bank_mask:0xf
    v_and_b32_dpp v30, v4, v38 row_newbcast:2 row_mask:0xf bank_mask:0xf
    v_and_b32_dpp v31, v4, v39 row_newbcast:2 row_mask:0xf bank_mask:0xf
    s_waitcnt vmcnt(29)
    s_nop 0
    v_mfma_f32_16x16x32_bf16 v[24:27], v[28:31], v[48:51], v[24:27]
    v_and_b32_dpp v32, v4, v36 row_newbcast:3 row_mask:0xf bank_mask:0xf
    v_and_b32_dpp v33, v4, v37 row_newbcast:3 row_mask:0xf bank_mask:0xf
    v_and_b32_dpp v34, v4, v38 row_newbcast:3 row_mask:0xf bank_mask:0xf
    v_and_b32_dpp v35, v4, v39 row_newbcast:3 row_mask:0xf bank_mask:0xf
    s_waitcnt vmcnt(28)
    s_nop 0
    v_mfma_f32_16x16x32_bf16 v[24:27], v[32:35], v[52:55], v[24:27]
    v_and_b32_dpp v28, v4, v36 row_newbcast:4 row_mask:0xf bank_mask:0xf
    v_and_b32_dpp v29, v4, v37 row_newbcast:4 row_mask:0xf bank_mask:0xf
    v_and_b32_dpp v30, v4, v38 row_newbcast:4 row_mask:0xf bank_mask:0xf
    v_and_b32_dpp v31, v4, v39 row_newbcast:4 row_mask:0xf bank_mask:0xf
    s_waitcnt vmcnt(27)
    s_nop 0
    v_mfma_f32_16x16x32_bf16 v[24:27], v[28:31], v[56:59], v[24:27]
    v_and_b32_dpp v32, v4, v36 row_newbcast:5 row_mask:0xf bank_mask:0xf
    v_and_b32_dpp v33, v4, v37 row_newbcast:5 row_mask:0xf bank_mask:0xf
    v_and_b32_dpp v34, v4, v38 row_newbcast:5 row_mask:0xf bank_mask:0xf
    v_and_b32_dpp v35, v4, v39 row_newbcast:5 row_mask:0xf bank_mask:0xf
    s_waitcnt vmcnt(26)
    s_nop 0
    v_mfma_f32_16x16x32_bf16 v[24:27], v[32:35], v[60:63], v[24:27]
    v_and_b32_dpp v28, v4, v36 row_newbcast:6 row_mask:0xf bank_mask:0xf
    v_and_b32_dpp v29, v4, v37 row_newbcast:6 row_mask:0xf bank_mask:0xf
    v_and_b32_dpp v30, v4, v38 row_newbcast:6 row_mask:0xf bank_mask:0xf
    v_and_b32_dpp v31, v4, v39 row_newbcast:6 row_mask:0xf bank_mask:0xf
    s_waitcnt vmcnt(25)
    s_nop 0
    v_mfma_f32_16x16x32_bf16 v[24:27], v[28:31], v[64:67], v[24:27]
    v_and_b32_dpp v32, v4, v36 row_newbcast:7 row_mask:0xf bank_mask:0xf
    v_and_b32_dpp v33, v4, v37 row_newbcast:7 row_mask:0xf bank_mask:0xf
    v_and_b32_dpp v34, v4, v38 row_newbcast:7 row_mask:0xf bank_mask:0xf
    v_and_b32_dpp v35, v4, v39 row_newbcast:7 row_mask:0xf bank_mask:0xf
    s_waitcnt vmcnt(24)
    s_nop 0
    v_mfma_f32_16x16x32_bf16 v[24:27], v[32:35], v[68:71], v[24:27]
    v_and_b32_dpp v28, v4, v36 row_newbcast:8 row_mask:0xf bank_mask:0xf
    v_and_b32_dpp v29, v4, v37 row_newbcast:8 row_mask:0xf bank_mask:0xf
    v_and_b32_dpp v30, v4, v38 row_newbcast:8 row_mask:0xf bank_mask:0xf
    v_and_b32_dpp v31, v4, v39 row_newbcast:8 row_mask:0xf bank_mask:0xf
    s_waitcnt vmcnt(23)
    s_nop 0
    v_mfma_f32_16x16x32_bf16 v[24:27], v[28:31], v[72:75], v[24:27]
    v_and_b32_dpp v32, v4, v36 row_newbcast:9 row_mask:0xf bank_mask:0xf
    v_and_b32_dpp v33, v4, v37 row_newbcast:9 row_mask:0xf bank_mask:0xf
    v_and_b32_dpp v34, v4, v38 row_newbcast:9 row_mask:0xf bank_mask:0xf
    v_and_b32_dpp v35, v4, v39 row_newbcast:9 row_mask:0xf bank_mask:0xf
    s_waitcnt vmcnt(22)
    s_nop 0
    v_mfma_f32_16x16x32_bf16 v[24:27], v[32:35], v[76:79], v[24:27]
    v_and_b32_dpp v28, v4, v36 row_newbcast:10 row_mask:0xf bank_mask:0xf
    v_and_b32_dpp v29, v4, v37 row_newbcast:10 row_mask:0xf bank_mask:0xf
    v_and_b32_dpp v30, v4, v38 row_newbcast:10 row_mask:0xf bank_mask:0xf
    v_and_b32_dpp v31, v4, v39 row_newbcast:10 row_mask:0xf bank_mask:0xf
    s_waitcnt vmcnt(21)
    s_nop 0
    v_mfma_f32_16x16x32_bf16 v[24:27], v[28:31], v[80:83], v[24:27]
    v_and_b32_dpp v32, v4, v36 row_newbcast:11 row_mask:0xf bank_mask:0xf
    v_and_b32_dpp v33, v4, v37 row_newbcast:11 row_mask:0xf bank_mask:0xf
    v_and_b32_dpp v34, v4, v38 row_newbcast:11 row_mask:0xf bank_mask:0xf
    v_and_b32_dpp v35, v4, v39 row_newbcast:11 row_mask:0xf bank_mask:0xf
    s_waitcnt vmcnt(20)
    s_nop 0
    v_mfma_f32_16x16x32_bf16 v[24:27], v[32:35], v[84:87], v[24:27]
    v_and_b32_dpp v28, v4, v36 row_newbcast:12 row_mask:0xf bank_mask:0xf
    v_and_b32_dpp v29, v4, v37 row_newbcast:12 row_mask:0xf bank_mask:0xf
    v_and_b32_dpp v30, v4, v38 row_newbcast:12 row_mask:0xf bank_mask:0xf
    v_and_b32_dpp v31, v4, v39 row_newbcast:12 row_mask:0xf bank_mask:0xf
    s_waitcnt vmcnt(19)
    s_nop 0
    v_mfma_f32_16x16x32_bf16 v[24:27], v[28:31], v[88:91], v[24:27]
    v_and_b32_dpp v32, v4, v36 row_newbcast:13 row_mask:0xf bank_mask:0xf
    v_and_b32_dpp v33, v4, v37 row_newbcast:13 row_mask:0xf bank_mask:0xf
    v_and_b32_dpp v34, v4, v38 row_newbcast:13 row_mask:0xf bank_mask:0xf
    v_and_b32_dpp v35, v4, v39 row_newbcast:13 row_mask:0xf bank_mask:0xf
    s_waitcnt vmcnt(18)
    s_nop 0
    v_mfma_f32_16x16x32_bf16 v[24:27], v[32:35], v[92:95], v[24:27]
    v_and_b32_dpp v28, v4, v36 row_newbcast:14 row_mask:0xf bank_mask:0xf
    v_and_b32_dpp v29, v4, v37 row_newbcast:14 row_mask:0xf bank_mask:0xf
    v_and_b32_dpp v30, v4, v38 row_newbcast:14 row_mask:0xf bank_mask:0xf
    v_and_b32_dpp v31, v4, v39 row_newbcast:14 row_mask:0xf bank_mask:0xf
    s_waitcnt vmcnt(17)
    s_nop 0
    v_mfma_f32_16x16x32_bf16 v[24:27], v[28:31], v[96:99], v[24:27]
    v_and_b32_dpp v32, v4, v36 row_newbcast:15 row_mask:0xf bank_mask:0xf
    v_and_b32_dpp v33, v4, v37 row_newbcast:15 row_mask:0xf bank_mask:0xf
    v_and_b32_dpp v34, v4, v38 row_newbcast:15 row_mask:0xf bank_mask:0xf
    v_and_b32_dpp v35, v4, v39 row_newbcast:15 row_mask:0xf bank_mask:0xf
    s_waitcnt vmcnt(16)
    s_nop 0
    v_mfma_f32_16x16x32_bf16 v[24:27], v[32:35], v[100:103], v[24:27]
    v_and_b32_dpp v28, v5, v36 row_newbcast:0 row_mask:0xf bank_mask:0xf
    v_and_b32_dpp v29, v5, v37 row_newbcast:0 row_mask:0xf bank_mask:0xf
    v_and_b32_dpp v30, v5, v38 row_newbcast:0 row_mask:0xf bank_mask:0xf
    v_and_b32_dpp v31, v5, v39 row_newbcast:0 row_mask:0xf bank_mask:0xf
    s_waitcnt vmcnt(15)
    s_nop 0
    v_mfma_f32_16x16x32_bf16 v[24:27], v[28:31], v[104:107], v[24:27]
    v_and_b32_dpp v32, v5, v36 row_newbcast:1 row_mask:0xf bank_mask:0xf
    v_and_b32_dpp v33, v5, v37 row_newbcast:1 row_mask:0xf bank_mask:0xf
    v_and_b32_dpp v34, v5, v38 row_newbcast:1 row_mask:0xf bank_mask:0xf
    v_and_b32_dpp v35, v5, v39 row_newbcast:1 row_mask:0xf bank_mask:0xf
    s_waitcnt vmcnt(14)
    s_nop 0
    v_mfma_f32_16x16x32_bf16 v[24:27], v[32:35], v[108:111], v[24:27]
    v_and_b32_dpp v28, v5, v36 row_newbcast:2 row_mask:0xf bank_mask:0xf
    v_and_b32_dpp v29, v5, v37 row_newbcast:2 row_mask:0xf bank_mask:0xf
    v_and_b32_dpp v30, v5, v38 row_newbcast:2 row_mask:0xf bank_mask:0xf
    v_and_b32_dpp v31, v5, v39 row_newbcast:2 row_mask:0xf bank_mask:0xf
    s_waitcnt vmcnt(13)
    s_nop 0
    v_mfma_f32_16x16x32_bf16 v[24:27], v[28:31], v[112:115], v[24:27]
    v_and_b32_dpp v32, v5, v36 row_newbcast:3 row_mask:0xf bank_mask:0xf
    v_and_b32_dpp v33, v5, v37 row_newbcast:3 row_mask:0xf bank_mask:0xf
    v_and_b32_dpp v34, v5, v38 row_newbcast:3 row_mask:0xf bank_mask:0xf
    v_and_b32_dpp v35, v5, v39 row_newbcast:3 row_mask:0xf bank_mask:0xf
    s_waitcnt vmcnt(12)
    s_nop 0
    v_mfma_f32_16x16x32_bf16 v[24:27], v[32:35], v[116:119], v[24:27]
    v_and_b32_dpp v28, v5, v36 row_newbcast:4 row_mask:0xf bank_mask:0xf
    v_and_b32_dpp v29, v5, v37 row_newbcast:4 row_mask:0xf bank_mask:0xf
    v_and_b32_dpp v30, v5, v38 row_newbcast:4 row_mask:0xf bank_mask:0xf
    v_and_b32_dpp v31, v5, v39 row_newbcast:4 row_mask:0xf bank_mask:0xf
    s_waitcnt vmcnt(11)
    s_nop 0
    v_mfma_f32_16x16x32_bf16 v[24:27], v[28:31], v[120:123], v[24:27]
    v_and_b32_dpp v32, v5, v36 row_newbcast:5 row_mask:0xf bank_mask:0xf
    v_and_b32_dpp v33, v5, v37 row_newbcast:5 row_mask:0xf bank_mask:0xf
    v_and_b32_dpp v34, v5, v38 row_newbcast:5 row_mask:0xf bank_mask:0xf
    v_and_b32_dpp v35, v5, v39 row_newbcast:5 row_mask:0xf bank_mask:0xf
    s_waitcnt vmcnt(10)
    s_nop 0
    v_mfma_f32_16x16x32_bf16 v[24:27], v[32:35], v[124:127], v[24:27]
    v_and_b32_dpp v28, v5, v36 row_newbcast:6 row_mask:0xf bank_mask:0xf
    v_and_b32_dpp v29, v5, v37 row_newbcast:6 row_mask:0xf bank_mask:0xf
    v_and_b32_dpp v30, v5, v38 row_newbcast:6 row_mask:0xf bank_mask:0xf
    v_and_b32_dpp v31, v5, v39 row_newbcast:6 row_mask:0xf bank_mask:0xf
    s_waitcnt vmcnt(9)
    s_nop 0
    v_mfma_f32_16x16x32_bf16 v[24:27], v[28:31], v[128:131], v[24:27]
    v_and_b32_dpp v32, v5, v36 row_newbcast:7 row_mask:0xf bank_mask:0xf
    v_and_b32_dpp v33, v5, v37 row_newbcast:7 row_mask:0xf bank_mask:0xf
    v_and_b32_dpp v34, v5, v38 row_newbcast:7 row_mask:0xf bank_mask:0xf
    v_and_b32_dpp v35, v5, v39 row_newbcast:7 row_mask:0xf bank_mask:0xf
    s_waitcnt vmcnt(8)
    s_nop 0
    v_mfma_f32_16x16x32_bf16 v[24:27], v[32:35], v[132:135], v[24:27]
    v_and_b32_dpp v28, v5, v36 row_newbcast:8 row_mask:0xf bank_mask:0xf
    v_and_b32_dpp v29, v5, v37 row_newbcast:8 row_mask:0xf bank_mask:0xf
    v_and_b32_dpp v30, v5, v38 row_newbcast:8 row_mask:0xf bank_mask:0xf
    v_and_b32_dpp v31, v5, v39 row_newbcast:8 row_mask:0xf bank_mask:0xf
    s_waitcnt vmcnt(7)
    s_nop 0
    v_mfma_f32_16x16x32_bf16 v[24:27], v[28:31], v[136:139], v[24:27]
    v_and_b32_dpp v32, v5, v36 row_newbcast:9 row_mask:0xf bank_mask:0xf
    v_and_b32_dpp v33, v5, v37 row_newbcast:9 row_mask:0xf bank_mask:0xf
    v_and_b32_dpp v34, v5, v38 row_newbcast:9 row_mask:0xf bank_mask:0xf
    v_and_b32_dpp v35, v5, v39 row_newbcast:9 row_mask:0xf bank_mask:0xf
    s_waitcnt vmcnt(6)
    s_nop 0
    v_mfma_f32_16x16x32_bf16 v[24:27], v[32:35], v[140:143], v[24:27]
    v_and_b32_dpp v28, v5, v36 row_newbcast:10 row_mask:0xf bank_mask:0xf
    v_and_b32_dpp v29, v5, v37 row_newbcast:10 row_mask:0xf bank_mask:0xf
    v_and_b32_dpp v30, v5, v38 row_newbcast:10 row_mask:0xf bank_mask:0xf
    v_and_b32_dpp v31, v5, v39 row_newbcast:10 row_mask:0xf bank_mask:0xf
    s_waitcnt vmcnt(5)
    s_nop 0
    v_mfma_f32_16x16x32_bf16 v[24:27], v[28:31], v[144:147], v[24:27]
    v_and_b32_dpp v32, v5, v36 row_newbcast:11 row_mask:0xf bank_mask:0xf
    v_and_b32_dpp v33, v5, v37 row_newbcast:11 row_mask:0xf bank_mask:0xf
    v_and_b32_dpp v34, v5, v38 row_newbcast:11 row_mask:0xf bank_mask:0xf
    v_and_b32_dpp v35, v5, v39 row_newbcast:11 row_mask:0xf bank_mask:0xf
    s_waitcnt vmcnt(4)
    s_nop 0
    v_mfma_f32_16x16x32_bf16 v[24:27], v[32:35], v[148:151], v[24:27]
    v_and_b32_dpp v28, v5, v36 row_newbcast:12 row_mask:0xf bank_mask:0xf
    v_and_b32_dpp v29, v5, v37 row_newbcast:12 row_mask:0xf bank_mask:0xf
    v_and_b32_dpp v30, v5, v38 row_newbcast:12 row_mask:0xf bank_mask:0xf
    v_and_b32_dpp v31, v5, v39 row_newbcast:12 row_mask:0xf bank_mask:0xf
    s_waitcnt vmcnt(3)
    s_nop 0
    v_mfma_f32_16x16x32_bf16 v[24:27], v[28:31], v[152:155], v[24:27]
    v_and_b32_dpp v32, v5, v36 row_newbcast:13 row_mask:0xf bank_mask:0xf
    v_and_b32_dpp v33, v5, v37 row_newbcast:13 row_mask:0xf bank_mask:0xf
    v_and_b32_dpp v34, v5, v38 row_newbcast:13 row_mask:0xf bank_mask:0xf
    v_and_b32_dpp v35, v5, v39 row_newbcast:13 row_mask:0xf bank_mask:0xf
    s_waitcnt vmcnt(2)
    s_nop 0
    v_mfma_f32_16x16x32_bf16 v[24:27], v[32:35], v[156:159], v[24:27]
    v_and_b32_dpp v28, v5, v36 row_newbcast:14 row_mask:0xf bank_mask:0xf
    v_and_b32_dpp v29, v5, v37 row_newbcast:14 row_mask:0xf bank_mask:0xf
    v_and_b32_dpp v30, v5, v38 row_newbcast:14 row_mask:0xf bank_mask:0xf
    v_and_b32_dpp v31, v5, v39 row_newbcast:14 row_mask:0xf bank_mask:0xf
    s_waitcnt vmcnt(1)
    s_nop 0
    v_mfma_f32_16x16x32_bf16 v[24:27], v[28:31], v[160:163], v[24:27]
    v_and_b32_dpp v32, v5, v36 row_newbcast:15 row_mask:0xf bank_mask:0xf
    v_and_b32_dpp v33, v5, v37 row_newbcast:15 row_mask:0xf bank_mask:0xf
    v_and_b32_dpp v34, v5, v38 row_newbcast:15 row_mask:0xf bank_mask:0xf
    v_and_b32_dpp v35, v5, v39 row_newbcast:15 row_mask:0xf bank_mask:0xf
    s_waitcnt vmcnt(0)
    s_nop 0
    v_mfma_f32_16x16x32_bf16 v[24:27], v[32:35], v[164:167], v[24:27]
    s_nop 7
    v_mul_f32 v24, v18, v24
    v_mul_f32 v25, v18, v25
    v_mul_f32 v26, v18, v26
    v_mul_f32 v27, v18, v27
    s_mov_b32 exec_lo, 0xffffffff
    s_mov_b32 exec_hi, 0x0
    ds_write_b128 v19, v[24:27] offset:2560
    s_mov_b64 exec, -1
    s_waitcnt lgkmcnt(0)
    s_barrier
    s_cmp_lg_u32 s61, 0
    s_cbranch_scc1 L_V_nopub
    s_mov_b32 exec_lo, 0xffffffff
    s_mov_b32 exec_hi, 0x1
    ds_read_b128 v[56:59], v2 offset:2560
    ds_read_b128 v[60:63], v2 offset:3088
    ds_read_b128 v[64:67], v2 offset:3616
    ds_read_b128 v[68:71], v2 offset:4144
    s_waitcnt lgkmcnt(2)
    v_add_f32 v56, v56, v60
    v_add_f32 v57, v57, v61
    v_add_f32 v58, v58, v62
    v_add_f32 v59, v59, v63
    s_waitcnt lgkmcnt(0)
    v_add_f32 v64, v64, v68
    v_add_f32 v65, v65, v69
    v_add_f32 v66, v66, v70
    v_add_f32 v67, v67, v71
    v_add_f32 v56, v56, v64
    v_add_f32 v57, v57, v65
    v_add_f32 v58, v58, v66
    v_add_f32 v59, v59, v67
    v_perm_b32 v56, v56, v3, s48
    v_perm_b32 v57, v57, v3, s49
    v_perm_b32 v58, v58, v3, s50
    v_perm_b32 v59, v59, v3, s51
    s_cmp_eq_u32 s65, 1
    s_cbranch_scc0 L_V_safe
    buffer_store_dwordx4 v[56:59], v2, s[36:39], s66 offen
L_V_pubd:
    s_mov_b64 exec, -1
L_V_nopub:
    s_cmp_lt_u32 s29, 16
    s_cbranch_scc0 L_V_nowo
    s_cmp_lt_u32 s61, 2
    s_cbranch_scc0 L_exit
    v_and_b32 v4, 7, v0
    v_lshrrev_b32 v5, 3, v0
    v_mul_u32_u24 v4, 272, v4
    v_lshl_add_u32 v4, v5, 4, v4
    s_lshl_b32 s53, s61, 7
    v_add_u32 v4, s53, v4
    v_lshlrev_b32 v5, 4, v5
    s_lshl_b32 s52, s28, 1
    s_lshr_b32 s54, s29, 3
    s_add_u32 s52, s52, s54
    s_mul_i32 s52, s52, 2176
    s_add_u32 s52, s52, s53
    s_lshl_b32 s53, s31, 8
    s_add_u32 s52, s52, s53
    s_add_u32 s52, s52, 0x90000
    v_bfe_u32 v6, v0, 2, 1
    v_bfe_u32 v7, v0, 1, 1
    v_lshl_add_u32 v7, v6, 1, v7
    v_lshl_add_u32 v6, v7, 2, v5
    v_add_u32 v7, 0x07060500, v7
    s_mov_b32 s54, 0xcccccccc
    s_mov_b32 s55, 0xcccccccc
    s_barrier
    ds_read_b128 v[56:59], v4 offset:4736
    s_waitcnt lgkmcnt(0)
    v_add_f32_dpp v60, v56, v56 row_shl:4 row_mask:0xf bank_mask:0x5
    v_add_f32_dpp v61, v57, v57 row_shl:4 row_mask:0xf bank_mask:0x5
    v_add_f32_dpp v60, v58, v58 row_shr:4 row_mask:0xf bank_mask:0xa
    v_add_f32_dpp v61, v59, v59 row_shr:4 row_mask:0xf bank_mask:0xa
    s_nop 0
    v_add_f32_dpp v60, v60, v60 quad_perm:[2,3,0,1] row_mask:0xf bank_mask:0xf
    v_add_f32_dpp v61, v61, v61 quad_perm:[2,3,0,1] row_mask:0xf bank_mask:0xf
    v_cndmask_b32 v60, v60, v61, s[54:55]
    s_nop 1
    v_add_f32_dpp v60, v60, v60 quad_perm:[1,0,3,2] row_mask:0xf bank_mask:0xf
    v_perm_b32 v60, v60, v3, v7
    s_mov_b32 exec_lo, 0x55555555
    s_mov_b32 exec_hi, 0x55555555
    buffer_store_dword v60, v6, s[36:39], s52 offen sc1
    s_branch L_exit
L_V_safe:
    buffer_store_dwordx4 v[56:59], v2, s[36:39], s66 offen sc1
    s_branch L_V_pubd
L_V_nowo:
    s_cmp_eq_u32 s63, 1
    s_cbranch_scc0 L_exit
    s_add_u32 s52, s64, 0
    buffer_load_dwordx4 v[40:43], v1, s[40:43], s52 offen
    s_add_u32 s52, s64, 4096
    buffer_load_dwordx4 v[44:47], v1, s[40:43], s52 offen
    s_add_u32 s52, s64, 8192
    buffer_load_dwordx4 v[48:51], v1, s[40:43], s52 offen
    s_add_u32 s52, s64, 12288
    buffer_load_dwordx4 v[52:55], v1, s[40:43], s52 offen
    s_barrier
    v_lshrrev_b32 v4, 4, v0
    v_and_b32 v5, 3, v0
    v_lshl_add_u32 v4, v5, 2, v4
    v_mul_u32_u24 v4, 40, v4
    v_bfe_u32 v5, v0, 2, 2
    v_lshl_add_u32 v4, v5, 3, v4
    v_and_b32 v5, 15, v0
    v_lshlrev_b32 v5, 5, v5
    v_lshrrev_b32 v6, 4, v0
    v_lshl_add_u32 v5, v6, 4, v5
    s_mul_i32 s52, s62, 2176
    s_lshl_b32 s53, s61, 9
    s_add_u32 s52, s52, s53
    s_add_u32 s52, s52, 0xa0000
    v_mov_b32 v20, 0xbdd2d3e8
    v_mov_b32 v21, 0xc0135761
    v_bfe_u32 v6, v0, 2, 2
    v_lshlrev_b32 v6, 3, v6
    v_mov_b32 v7, 0
    s_waitcnt vmcnt(0)
    s_barrier
    ds_read_b64 v[16:17], v6 offset:7336
    ds_read_b64 v[18:19], v6 offset:7296
    ds_read_b32 v22, v7 offset:7336
    ds_read_b64 v[8:9], v4 offset:4736
    ds_read_b64 v[10:11], v4 offset:5376
    ds_read_b64 v[12:13], v4 offset:6016
    ds_read_b64 v[14:15], v4 offset:6656
    s_waitcnt lgkmcnt(4)
    v_mul_f32 v23, 0xbc800000, v16
    v_mul_f32 v28, 0xbc800000, v17
    v_fmac_f32 v18, v23, v16
    v_fmac_f32 v19, v28, v17
    v_sub_f32 v16, v16, v22
    v_sub_f32 v17, v17, v22
    v_mul_f32 v23, 0x3c800000, v16
    v_mul_f32 v28, 0x3c800000, v17
    v_fmac_f32 v18, v23, v16
    v_fmac_f32 v19, v28, v17
    v_add_f32 v16, v16, v17
    v_add_f32 v18, v18, v19
    s_waitcnt lgkmcnt(0)
    v_add_f32 v8, v8, v9
    v_add_f32 v10, v10, v11
    v_add_f32 v12, v12, v13
    v_add_f32 v14, v14, v15
    v_add_f32_dpp v16, v16, v16 row_ror:4 row_mask:0xf bank_mask:0xf
    v_add_f32_dpp v18, v18, v18 row_ror:4 row_mask:0xf bank_mask:0xf
    v_add_f32_dpp v8, v8, v8 row_ror:4 row_mask:0xf bank_mask:0xf
    v_add_f32_dpp v10, v10, v10 row_ror:4 row_mask:0xf bank_mask:0xf
    v_add_f32_dpp v12, v12, v12 row_ror:4 row_mask:0xf bank_mask:0xf
    v_add_f32_dpp v14, v14, v14 row_ror:4 row_mask:0xf bank_mask:0xf
    v_add_f32_dpp v16, v16, v16 row_ror:8 row_mask:0xf bank_mask:0xf
    v_add_f32_dpp v18, v18, v18 row_ror:8 row_mask:0xf bank_mask:0xf
    v_add_f32_dpp v8, v8, v8 row_ror:8 row_mask:0xf bank_mask:0xf
    v_add_f32_dpp v10, v10, v10 row_ror:8 row_mask:0xf bank_mask:0xf
    v_add_f32_dpp v12, v12, v12 row_ror:8 row_mask:0xf bank_mask:0xf
    v_add_f32_dpp v14, v14, v14 row_ror:8 row_mask:0xf bank_mask:0xf
    v_mul_f32 v16, 0x3b000000, v16
    v_mul_f32 v18, 0x3b000000, v18
    v_fma_f32 v18, -v16, v16, v18
    v_fmac_f32 v16, 0x3c800000, v22
    v_max_f32 v18, 0, v18
    v_cvt_pk_bf16_f32 v17, v16, v18
    v_and_b32 v18, 0xffff0000, v17
    v_lshlrev_b32 v16, 16, v17
    v_add_f32 v18, 0x3727c5ac, v18
    v_fma_f32 v8, -v16, v12, v8
    v_cvt_pk_bf16_f32 v18, v18, v18
    v_fma_f32 v10, -v16, v14, v10
    v_and_b32 v18, 0xffff0000, v18
    v_sqrt_f32 v18, v18
    s_nop 0
    v_cvt_pk_bf16_f32 v18, v18, v18
    v_and_b32 v18, 0xffff0000, v18
    v_rcp_f32 v18, v18
    s_nop 0
    v_mul_f32 v8, v8, v18
    v_mul_f32 v10, v10, v18
    v_cvt_pk_bf16_f32 v12, v8, v10
    v_and_b32 v10, 0xffff0000, v12
    v_lshlrev_b32 v8, 16, v12
    v_mul_f32 v9, v8, v8
    v_fma_f32 v9, v9, v20, v21
    v_mul_f32 v9, v9, v8
    v_exp_f32 v9, v9
    s_nop 0
    v_add_f32 v9, 1.0, v9
    v_rcp_f32 v9, v9
    s_nop 0
    v_mul_f32 v9, v9, v8
    v_cvt_pk_bf16_f32 v9, v9, v9
    v_and_b32 v9, 0xffff0000, v9
    v_mul_f32 v9, v9, v10
    v_cvt_pk_bf16_f32 v4, v9, v9
    s_nop 1
    v_and_b32_dpp v28, v4, v36 row_newbcast:0 row_mask:0xf bank_mask:0xf
    v_and_b32_dpp v29, v4, v37 row_newbcast:0 row_mask:0xf bank_mask:0xf
    v_and_b32_dpp v30, v4, v38 row_newbcast:0 row_mask:0xf bank_mask:0xf
    v_and_b32_dpp v31, v4, v39 row_newbcast:0 row_mask:0xf bank_mask:0xf
    s_nop 1
    v_mfma_f32_16x16x32_bf16 v[24:27], v[28:31], v[40:43], 0
    v_and_b32_dpp v32, v4, v36 row_newbcast:1 row_mask:0xf bank_mask:0xf
    v_and_b32_dpp v33, v4, v37 row_newbcast:1 row_mask:0xf bank_mask:0xf
    v_and_b32_dpp v34, v4, v38 row_newbcast:1 row_mask:0xf bank_mask:0xf
    v_and_b32_dpp v35, v4, v39 row_newbcast:1 row_mask:0xf bank_mask:0xf
    s_nop 1
    v_mfma_f32_16x16x32_bf16 v[24:27], v[32:35], v[44:47], v[24:27]
    v_and_b32_dpp v28, v4, v36 row_newbcast:2 row_mask:0xf bank_mask:0xf
    v_and_b32_dpp v29, v4, v37 row_newbcast:2 row_mask:0xf bank_mask:0xf
    v_and_b32_dpp v30, v4, v38 row_newbcast:2 row_mask:0xf bank_mask:0xf
    v_and_b32_dpp v31, v4, v39 row_newbcast:2 row_mask:0xf bank_mask:0xf
    s_nop 1
    v_mfma_f32_16x16x32_bf16 v[24:27], v[28:31], v[48:51], v[24:27]
    v_and_b32_dpp v32, v4, v36 row_newbcast:3 row_mask:0xf bank_mask:0xf
    v_and_b32_dpp v33, v4, v37 row_newbcast:3 row_mask:0xf bank_mask:0xf
    v_and_b32_dpp v34, v4, v38 row_newbcast:3 row_mask:0xf bank_mask:0xf
    v_and_b32_dpp v35, v4, v39 row_newbcast:3 row_mask:0xf bank_mask:0xf
    s_nop 1
    v_mfma_f32_16x16x32_bf16 v[24:27], v[32:35], v[52:55], v[24:27]
    s_mov_b32 exec_lo, 0xffffffff
    s_mov_b32 exec_hi, 0x0
    s_nop 5
    v_perm_b32 v24, v24, v3, s48
    v_perm_b32 v25, v25, v3, s49
    v_perm_b32 v26, v26, v3, s50
    v_perm_b32 v27, v27, v3, s51
    buffer_store_dwordx4 v[24:27], v5, s[36:39], s52 offen sc1
    s_branch L_exit

L_H:
    s_mov_b32 s36, s26
    s_and_b32 s37, s27, 0xffff
    s_mov_b32 s38, 0x200000
    s_mov_b32 s39, 0x20000
    s_cmp_eq_u32 s3, 1
    s_cbranch_scc0 L_H_notok
    s_mov_b32 s48, 0x7060500
    s_mov_b32 s49, 0x7060501
    s_mov_b32 s50, 0x7060502
    s_mov_b32 s51, 0x7060503
    s_getreg_b32 s67, hwreg(HW_REG_XCC_ID, 0, 4)
    s_lshl_b32 s67, s67, 8
    s_lshl_b32 s66, s28, 12
    s_add_u32 s66, s66, 0x1000
    s_lshl_b32 s52, s29, 7
    s_add_u32 s52, s52, s66
    v_mov_b32 v104, s67
    v_mov_b32 v105, s67
    v_mov_b32 v106, s67
    v_mov_b32 v107, s67
    v_mov_b32 v108, 0
    s_waitcnt lgkmcnt(0)
    s_add_u32 s53, s44, 0x9e3779b1
    v_mov_b32 v109, s53
    v_perm_b32 v104, v104, v109, s48
    v_perm_b32 v105, v105, v109, s49
    v_perm_b32 v106, v106, v109, s50
    v_perm_b32 v107, v107, v109, s51
    s_mov_b64 exec, 1
    buffer_store_dwordx4 v[104:107], v108, s[36:39], s52 offen
    s_mov_b64 exec, -1
    s_mov_b32 s64, 1
    s_branch L_H_tok
L_H_notok:
    s_mov_b32 s64, 0
L_H_tok:
    v_bfe_u32 v13, v0, 1, 3
    v_and_b32 v14, 1, v0
    v_lshlrev_b32 v14, 4, v14
    v_mov_b32 v15, 0xffff
    v_lshlrev_b32 v14, v14, v15
    v_cmp_eq_u32 vcc, 0, v13
    s_nop 1
    v_cndmask_b32 v88, 0, v14, vcc
    v_cmp_eq_u32 vcc, 1, v13
    s_nop 1
    v_cndmask_b32 v89, 0, v14, vcc
    v_cmp_eq_u32 vcc, 2, v13
    s_nop 1
    v_cndmask_b32 v90, 0, v14, vcc
    v_cmp_eq_u32 vcc, 3, v13
    s_nop 1
    v_cndmask_b32 v91, 0, v14, vcc
    s_cmp_eq_u32 s64, 1
    s_cbranch_scc1 L_H_w1
    s_waitcnt vmcnt(4)
    s_branch L_H_w2
L_H_w1:
    s_waitcnt vmcnt(5)
L_H_w2:
    v_and_b32 v81, 0xffff0000, v8
    v_lshlrev_b32 v80, 16, v8
    v_and_b32 v83, 0xffff0000, v9
    v_lshlrev_b32 v82, 16, v9
    v_and_b32 v85, 0xffff0000, v10
    v_lshlrev_b32 v84, 16, v10
    v_and_b32 v87, 0xffff0000, v11
    v_lshlrev_b32 v86, 16, v11
    v_add_f32 v8, v80, v81
    v_add_f32 v9, v82, v83
    v_add_f32 v10, v84, v85
    v_add_f32 v11, v86, v87
    v_add_f32 v8, v8, v9
    v_add_f32 v10, v10, v11
    v_add_f32 v8, v8, v10
    s_nop 1
    v_add_f32_dpp v8, v8, v8 quad_perm:[1,0,3,2] row_mask:0xf bank_mask:0xf
    s_nop 1
    v_add_f32_dpp v8, v8, v8 quad_perm:[2,3,0,1] row_mask:0xf bank_mask:0xf
    s_nop 1
    v_add_f32_dpp v8, v8, v8 row_half_mirror row_mask:0xf bank_mask:0xf
    s_nop 1
    v_add_f32_dpp v8, v8, v8 row_mirror row_mask:0xf bank_mask:0xf
    v_mov_b32 v9, v8
    s_nop 1
    v_permlane16_swap_b32 v9, v8
    v_add_f32 v8, v8, v9
    v_mov_b32 v9, v8
    s_nop 1
    v_permlane32_swap_b32 v9, v8
    v_add_f32 v8, v8, v9
    v_mul_f32 v8, 0x3b000000, v8
    v_sub_f32 v80, v80, v8
    v_sub_f32 v81, v81, v8
    v_sub_f32 v82, v82, v8
    v_sub_f32 v83, v83, v8
    v_sub_f32 v84, v84, v8
    v_sub_f32 v85, v85, v8
    v_sub_f32 v86, v86, v8
    v_sub_f32 v87, v87, v8
    v_mul_f32 v9, v80, v80
    v_fmac_f32 v9, v81, v81
    v_fmac_f32 v9, v82, v82
    v_fmac_f32 v9, v83, v83
    v_fmac_f32 v9, v84, v84
    v_fmac_f32 v9, v85, v85
    v_fmac_f32 v9, v86, v86
    v_fmac_f32 v9, v87, v87
    s_nop 1
    v_add_f32_dpp v9, v9, v9 quad_perm:[1,0,3,2] row_mask:0xf bank_mask:0xf
    s_nop 1
    v_add_f32_dpp v9, v9, v9 quad_perm:[2,3,0,1] row_mask:0xf bank_mask:0xf
    s_nop 1
    v_add_f32_dpp v9, v9, v9 row_half_mirror row_mask:0xf bank_mask:0xf
    s_nop 1
    v_add_f32_dpp v9, v9, v9 row_mirror row_mask:0xf bank_mask:0xf
    v_mov_b32 v10, v9
    s_nop 1
    v_permlane16_swap_b32 v10, v9
    v_add_f32 v9, v9, v10
    v_mov_b32 v10, v9
    s_nop 1
    v_permlane32_swap_b32 v10, v9
    v_add_f32 v9, v9, v10
    v_mul_f32 v9, 0x3b000000, v9
    v_cvt_pk_bf16_f32 v10, v8, v9
    v_and_b32 v9, 0xffff0000, v10
    v_lshlrev_b32 v8, 16, v10
    v_add_f32 v9, 0x3727c5ac, v9
    v_cvt_pk_bf16_f32 v9, v9, v9
    v_and_b32 v9, 0xffff0000, v9
    v_sqrt_f32 v9, v9
    v_lshlrev_b32 v12, 16, v12
    v_sub_f32 v12, v12, v8
    v_cvt_pk_bf16_f32 v9, v9, v9
    v_and_b32 v9, 0xffff0000, v9
    v_cvt_pk_bf16_f32 v12, v12, v12
    v_and_b32 v12, 0xffff0000, v12
    v_rcp_f32 v10, v9
    s_nop 0
    v_mul_f32 v11, v12, v10
    v_fma_f32 v13, -v11, v9, v12
    v_fma_f32 v11, v13, v10, v11
    v_cvt_pk_bf16_f32 v12, v11, v11
    s_cmp_eq_u32 s64, 1
    s_cbranch_scc1 L_H_w3
    s_waitcnt vmcnt(0)
    s_branch L_H_w4
L_H_w3:
    s_waitcnt vmcnt(1)
L_H_w4:
    v_and_b32_dpp v96, v12, v88 row_newbcast:0 row_mask:0xf bank_mask:0xf
    v_and_b32_dpp v97, v12, v89 row_newbcast:0 row_mask:0xf bank_mask:0xf
    v_and_b32_dpp v98, v12, v90 row_newbcast:0 row_mask:0xf bank_mask:0xf
    v_and_b32_dpp v99, v12, v91 row_newbcast:0 row_mask:0xf bank_mask:0xf
    s_nop 1
    v_mfma_f32_16x16x32_bf16 v[92:95], v[96:99], v[16:19], 0
    v_and_b32_dpp v100, v12, v88 row_newbcast:1 row_mask:0xf bank_mask:0xf
    v_and_b32_dpp v101, v12, v89 row_newbcast:1 row_mask:0xf bank_mask:0xf
    v_and_b32_dpp v102, v12, v90 row_newbcast:1 row_mask:0xf bank_mask:0xf
    v_and_b32_dpp v103, v12, v91 row_newbcast:1 row_mask:0xf bank_mask:0xf
    s_nop 1
    v_mfma_f32_16x16x32_bf16 v[92:95], v[100:103], v[20:23], v[92:95]
    v_and_b32_dpp v96, v12, v88 row_newbcast:2 row_mask:0xf bank_mask:0xf
    v_and_b32_dpp v97, v12, v89 row_newbcast:2 row_mask:0xf bank_mask:0xf
    v_and_b32_dpp v98, v12, v90 row_newbcast:2 row_mask:0xf bank_mask:0xf
    v_and_b32_dpp v99, v12, v91 row_newbcast:2 row_mask:0xf bank_mask:0xf
    s_nop 1
    v_mfma_f32_16x16x32_bf16 v[92:95], v[96:99], v[24:27], v[92:95]
    v_and_b32_dpp v100, v12, v88 row_newbcast:3 row_mask:0xf bank_mask:0xf
    v_and_b32_dpp v101, v12, v89 row_newbcast:3 row_mask:0xf bank_mask:0xf
    v_and_b32_dpp v102, v12, v90 row_newbcast:3 row_mask:0xf bank_mask:0xf
    v_and_b32_dpp v103, v12, v91 row_newbcast:3 row_mask:0xf bank_mask:0xf
    s_nop 1
    v_mfma_f32_16x16x32_bf16 v[92:95], v[100:103], v[28:31], v[92:95]
    s_waitcnt lgkmcnt(0)
    s_add_u32 s44, s44, 0x9e3779b1
    s_and_b32 s68, s44, 0xff
    s_bfe_u32 s45, s44, 0x80008
    s_bfe_u32 s46, s44, 0x80010
    s_lshr_b32 s47, s44, 24
    s_cmp_eq_u32 s3, 0
    s_cbranch_scc1 L_H0
    s_lshl_b32 s52, s61, 9
    v_add_u32 v5, s52, v2
    s_lshl_b32 s52, s61, 2
    v_mov_b32 v6, s52
    v_mov_b32 v7, 1
    s_mov_b32 exec_lo, 0xffffffff
    s_mov_b32 exec_hi, 0x0
    ds_write_b128 v5, v[92:95] offset:5888
    s_waitcnt lgkmcnt(0)
    s_mov_b64 exec, 1
    ds_write_b32 v6, v7 offset:6272
    s_mov_b64 exec, -1
    s_branch L_H123
L_H0:
    v_lshlrev_b32 v4, 6, v4
    v_lshl_add_u32 v4, v3, 5, v4
    s_lshl_b32 s53, s30, 13
    s_add_u32 s53, s53, 0x10000
    s_lshl_b32 s58, s31, 10
    s_add_u32 s58, s58, s53
    v_mov_b32 v5, 0
    s_mov_b32 s60, 0
L_H0_join:
    ds_read_b128 v[8:11], v5 offset:6272
    s_waitcnt lgkmcnt(0)
    v_and_b32 v9, v9, v10
    v_and_b32 v9, v9, v11
    v_cmp_ne_u32 vcc, 1, v9
    s_cbranch_vccz L_H0_joined
    s_add_u32 s60, s60, 1
    s_cmp_lt_u32 s60, 1000000
    s_cbranch_scc1 L_H0_join
L_H0_joined:
    ds_read_b128 v[16:19], v2 offset:6400
    ds_read_b128 v[20:23], v2 offset:6912
    ds_read_b128 v[24:27], v2 offset:7424
    v_mov_b32 v9, s44
    v_mov_b32 v11, s44
    v_mov_b32 v13, s44
    v_mov_b32 v15, s44
    s_waitcnt lgkmcnt(0)
    v_add_f32 v92, v92, v16
    v_add_f32 v20, v20, v24
    v_add_f32 v93, v93, v17
    v_add_f32 v21, v21, v25
    v_add_f32 v94, v94, v18
    v_add_f32 v22, v22, v26
    v_add_f32 v95, v95, v19
    v_add_f32 v23, v23, v27
    v_add_f32 v8, v92, v20
    v_add_f32 v10, v93, v21
    v_add_f32 v12, v94, v22
    v_add_f32 v14, v95, v23
    s_mov_b32 exec_lo, 0xffffffff
    s_mov_b32 exec_hi, 0x0
    buffer_store_dwordx4 v[8:11], v4, s[36:39], s58 offen
    buffer_store_dwordx4 v[12:15], v4, s[36:39], s58 offen offset:16
    s_mov_b64 exec, -1
    s_mov_b32 s65, 0
    s_add_u32 s52, s53, 4096
    s_mov_b32 s60, 0
    s_sleep 25
L_H0_poll:
    buffer_load_dwordx4 v[16:19], v2, s[36:39], s53 offen offset:0 sc1
    buffer_load_dwordx4 v[20:23], v2, s[36:39], s53 offen offset:1024 sc1
    buffer_load_dwordx4 v[24:27], v2, s[36:39], s53 offen offset:2048 sc1
    buffer_load_dwordx4 v[28:31], v2, s[36:39], s53 offen offset:3072 sc1
    buffer_load_dwordx4 v[32:35], v2, s[36:39], s52 offen offset:0 sc1
    buffer_load_dwordx4 v[36:39], v2, s[36:39], s52 offen offset:1024 sc1
    buffer_load_dwordx4 v[40:43], v2, s[36:39], s52 offen offset:2048 sc1
    buffer_load_dwordx4 v[44:47], v2, s[36:39], s52 offen offset:3072 sc1
    s_waitcnt vmcnt(7)
    v_xor_b32 v62, s44, v17
    v_bitop3_b32 v62, v62, v19, s44 bitop3:0xf6
    s_waitcnt vmcnt(6)
    v_bitop3_b32 v62, v62, v21, s44 bitop3:0xf6
    v_bitop3_b32 v62, v62, v23, s44 bitop3:0xf6
    s_waitcnt vmcnt(5)
    v_bitop3_b32 v62, v62, v25, s44 bitop3:0xf6
    v_bitop3_b32 v62, v62, v27, s44 bitop3:0xf6
    s_waitcnt vmcnt(4)
    v_bitop3_b32 v62, v62, v29, s44 bitop3:0xf6
    v_bitop3_b32 v62, v62, v31, s44 bitop3:0xf6
    s_waitcnt vmcnt(3)
    v_bitop3_b32 v62, v62, v33, s44 bitop3:0xf6
    v_bitop3_b32 v62, v62, v35, s44 bitop3:0xf6
    s_waitcnt vmcnt(2)
    v_bitop3_b32 v62, v62, v37, s44 bitop3:0xf6
    v_bitop3_b32 v62, v62, v39, s44 bitop3:0xf6
    s_waitcnt vmcnt(1)
    v_bitop3_b32 v62, v62, v41, s44 bitop3:0xf6
    v_bitop3_b32 v62, v62, v43, s44 bitop3:0xf6
    s_waitcnt vmcnt(0)
    v_bitop3_b32 v62, v62, v45, s44 bitop3:0xf6
    v_bitop3_b32 v62, v62, v47, s44 bitop3:0xf6
    v_cmp_ne_u32 vcc, 0, v62
    s_cbranch_vccz L_H0_got
    s_cmp_eq_u32 s65, 1
    s_cbranch_scc1 L_rep_1
    ds_read_b64 v[6:7], v5 offset:264
    s_waitcnt lgkmcnt(0)
    v_readfirstlane_b32 s64, v7
    v_readfirstlane_b32 s59, v6
    s_cmp_eq_u32 s64, 1
    s_cbranch_scc0 L_rep_1
    s_mov_b32 s65, 1
    s_cmp_eq_u32 s59, 1
    s_cbranch_scc1 L_rep_1
    s_mov_b32 exec_lo, 0xffffffff
    s_mov_b32 exec_hi, 0x0
    buffer_store_dwordx4 v[8:11], v4, s[36:39], s58 offen sc1
    buffer_store_dwordx4 v[12:15], v4, s[36:39], s58 offen offset:16 sc1
    s_mov_b64 exec, -1
L_rep_1:
    s_add_u32 s60, s60, 1
    s_cmp_lt_u32 s60, 1000000
    s_sleep 4
    s_cbranch_scc1 L_H0_poll
L_H0_got:
    v_add_f32 v16, v16, v20
    v_add_f32 v18, v18, v22
    v_add_f32 v16, v16, v24
    v_add_f32 v18, v18, v26
    v_add_f32 v16, v16, v28
    v_add_f32 v18, v18, v30
    v_add_f32 v16, v16, v32
    v_add_f32 v18, v18, v34
    v_add_f32 v16, v16, v36
    v_add_f32 v18, v18, v38
    v_add_f32 v16, v16, v40
    v_add_f32 v18, v18, v42
    v_add_f32 v16, v16, v44
    v_add_f32 v18, v18, v46
    v_cvt_pk_bf16_f32 v16, v16, v18
    v_lshlrev_b32 v3, 2, v0
    v_mov_b32 v6, 1
    ds_write_b32 v3, v16 offset:0
    s_waitcnt lgkmcnt(0)
    s_mov_b64 exec, 1
    ds_write_b32 v5, v6 offset:256
    s_mov_b64 exec, -1
    s_waitcnt lgkmcnt(0)
    s_mov_b32 s60, 0
L_H0_mode:
    ds_read_b32 v6, v5 offset:268
    s_waitcnt lgkmcnt(0)
    v_readfirstlane_b32 s52, v6
    s_cmp_eq_u32 s52, 1
    s_cbranch_scc1 L_H0_mode_ok
    s_sleep 4
    s_add_u32 s60, s60, 1
    s_cmp_lt_u32 s60, 1000000
    s_cbranch_scc1 L_H0_mode
L_H0_mode_ok:
    s_cmp_eq_u32 s65, 1
    s_cbranch_scc1 L_rep_2
    ds_read_b64 v[6:7], v5 offset:264
    s_waitcnt lgkmcnt(0)
    v_readfirstlane_b32 s64, v7
    v_readfirstlane_b32 s59, v6
    s_cmp_eq_u32 s64, 1
    s_cbranch_scc0 L_rep_2
    s_mov_b32 s65, 1
    s_cmp_eq_u32 s59, 1
    s_cbranch_scc1 L_rep_2
    s_mov_b32 exec_lo, 0xffffffff
    s_mov_b32 exec_hi, 0x0
    buffer_store_dwordx4 v[8:11], v4, s[36:39], s58 offen sc1
    buffer_store_dwordx4 v[12:15], v4, s[36:39], s58 offen offset:16 sc1
    s_mov_b64 exec, -1
L_rep_2:
    s_branch L_T
L_H123:
    s_cmp_eq_u32 s3, 1
    s_cbranch_scc0 L_T
    v_and_b32 v3, 31, v0
    v_lshlrev_b32 v3, 7, v3
    s_sleep 16
    s_mov_b32 s60, 0
    v_mov_b32 v63, 0
L_H1_poll:
    buffer_load_dwordx4 v[4:7], v3, s[36:39], s66 offen sc1
    s_waitcnt vmcnt(0)
    v_xor_b32 v4, s68, v4
    v_xor_b32 v5, s45, v5
    v_xor_b32 v6, s46, v6
    v_xor_b32 v7, s47, v7
    v_or_b32 v62, v4, v5
    v_or3_b32 v62, v62, v6, v7
    v_cmp_ne_u32_sdwa vcc, v62, v63 src0_sel:BYTE_0 src1_sel:DWORD
    s_and_b64 exec, vcc, vcc
    s_cbranch_scc0 L_H1_poll_ok
    s_add_u32 s60, s60, 1
    s_cmp_lt_u32 s60, 12
    s_sleep 8
    s_cbranch_scc1 L_H1_poll
L_H1_poll_ok:
    s_mov_b64 exec, -1
    s_cmp_lt_u32 s60, 12
    s_cselect_b32 s67, s67, -1
    v_cmp_ne_u32 vcc, s67, v4
    s_cmp_eq_u64 vcc, 0
    s_cselect_b32 s52, 1, 0
    v_mov_b32 v4, s52
    v_mov_b32 v5, 1
    v_mov_b32 v9, 0
    s_mov_b64 exec, 1
    ds_write_b64 v9, v[4:5] offset:264
    s_mov_b64 exec, -1
    s_waitcnt lgkmcnt(0)

L_T:
    s_setprio 0
    s_lshr_b32 s52, s28, 1
    s_mul_i32 s67, s52, 16
    s_mul_i32 s53, s52, 6
    s_add_u32 s53, s53, 64
    s_bitcmp1_b32 s28, 0
    s_cselect_b32 s67, s53, s67
    s_cselect_b32 s69, 6, 16
    s_sub_u32 s52, s29, 16
    s_add_u32 s62, s67, s52
    s_cmp_lt_u32 s52, s69
    s_cselect_b32 s53, 1, 0
    s_cmp_lt_u32 s62, 86
    s_cselect_b32 s63, s53, 0
    s_mov_b32 s54, 0xcccccccc
    s_mov_b32 s55, 0xcccccccc
    s_mov_b32 s56, 0xaaaaaaaa
    s_mov_b32 s57, 0xaaaaaaaa
    v_lshrrev_b32 v3, 4, v0
    v_lshrrev_b32 v4, 3, v0
    v_and_b32 v5, 7, v0
    v_bfe_u32 v7, v0, 2, 2
    v_lshl_add_u32 v7, v7, 2, v3
    v_lshlrev_b32 v7, 6, v7
    v_and_b32 v8, 3, v0
    v_lshl_add_u32 v7, v8, 3, v7
    s_lshl_b32 s61, s3, 12
    s_add_u32 s61, s61, 8192
    v_add_u32 v7, s61, v7
    v_lshrrev_b32 v9, 2, v0
    s_cmp_lt_u32 s29, 16
    s_cbranch_scc1 L_T_wo
    s_cmp_eq_u32 s63, 1
    s_cbranch_scc1 L_T_ffn
    s_sub_u32 s52, s29, 22
    s_cmp_lt_u32 s52, 8
    s_cselect_b32 s53, 1, 0
    s_bitcmp1_b32 s28, 0
    s_cselect_b32 s53, s53, 0
    s_cmp_lt_u32 s3, 2
    s_cselect_b32 s53, s53, 0
    s_cmp_eq_u32 s53, 1
    s_cbranch_scc1 L_T_fin
    s_barrier
    s_barrier
    s_cmp_eq_u32 s3, 3
    s_cbranch_scc0 L_pf_3
    v_and_b32 v100, 7, v0
    v_lshlrev_b32 v100, 7, v100
    s_lshl_b32 s52, s69, 5
    s_sub_u32 s52, s52, 4
    v_min_u32 v100, s52, v100
    v_lshrrev_b32 v102, 3, v0
    v_mul_u32_u24 v102, 2752, v102
    v_add_u32 v100, v100, v102
    s_sub_u32 s52, s29, 16
    s_mul_i32 s52, s52, 88064
    s_lshl_b32 s53, s67, 5
    s_add_u32 s53, s53, s52
    s_mov_b32 s40, s16
    s_and_b32 s41, s17, 0xffff
    s_mov_b32 s42, 1409024
    s_mov_b32 s43, 0x20000
    s_add_u32 s52, s53, 0
    buffer_load_dword v101, v100, s[40:43], s52 offen
    s_add_u32 s52, s53, 22016
    buffer_load_dword v101, v100, s[40:43], s52 offen
    s_add_u32 s52, s53, 44032
    buffer_load_dword v101, v100, s[40:43], s52 offen
    s_add_u32 s52, s53, 66048
    buffer_load_dword v101, v100, s[40:43], s52 offen
    s_mov_b32 s40, s18
    s_and_b32 s41, s19, 0xffff
    s_mov_b32 s42, 1409024
    s_mov_b32 s43, 0x20000
    s_add_u32 s52, s53, 0
    buffer_load_dword v101, v100, s[40:43], s52 offen
    s_add_u32 s52, s53, 22016
    buffer_load_dword v101, v100, s[40:43], s52 offen
    s_add_u32 s52, s53, 44032
    buffer_load_dword v101, v100, s[40:43], s52 offen
    s_add_u32 s52, s53, 66048
    buffer_load_dword v101, v100, s[40:43], s52 offen
L_pf_3:
    s_branch L_exit

L_T_wo:
    v_lshlrev_b32 v10, 10, v4
    v_lshl_add_u32 v10, v5, 4, v10
    s_lshl_b32 s52, s28, 1
    s_lshr_b32 s53, s29, 3
    s_add_u32 s52, s52, s53
    s_lshl_b32 s58, s52, 3
    s_add_u32 s58, s58, s3
    s_lshl_b32 s64, s58, 15
    s_lshl_b32 s53, s31, 7
    s_add_u32 s64, s64, s53
    v_bfe_u32 v7, v0, 2, 2
    v_lshl_add_u32 v7, v7, 2, v3
    v_lshlrev_b32 v7, 7, v7
    v_lshl_add_u32 v7, v8, 3, v7
    v_add_u32 v7, s61, v7
    v_mul_u32_u24 v11, 640, v4
    v_lshl_add_u32 v12, v5, 4, v11
    s_lshr_b32 s58, s58, 2
    s_mul_i32 s58, s58, 5120
    s_add_u32 s58, s58, 0x50000
    s_and_b32 s53, s3, 3
    s_lshl_b32 s53, s53, 7
    s_add_u32 s59, s53, s58
    v_lshlrev_b32 v13, 2, v0
    s_mul_i32 s53, s3, 272
    v_add_u32 v13, s53, v13
    s_barrier
    s_mov_b32 s40, s12
    s_and_b32 s41, s13, 0xffff
    s_mov_b32 s42, 0x400000
    s_mov_b32 s43, 0x20000
    s_add_u32 m0, s61, 0
    s_add_u32 s53, s64, 0
    buffer_load_dwordx4 v10, s[40:43], s53 offen lds
    s_add_u32 m0, s61, 1024
    s_add_u32 s53, s64, 8192
    buffer_load_dwordx4 v10, s[40:43], s53 offen lds
    s_add_u32 m0, s61, 2048
    s_add_u32 s53, s64, 16384
    buffer_load_dwordx4 v10, s[40:43], s53 offen lds
    s_add_u32 m0, s61, 3072
    s_add_u32 s53, s64, 24576
    buffer_load_dwordx4 v10, s[40:43], s53 offen lds
    s_barrier
    s_mov_b32 s60, 0
    v_mov_b32 v63, 0
    buffer_load_dwordx4 v[32:35], v11, s[36:39], s58 offen offset:512 sc1
    buffer_load_dwordx4 v[36:39], v12, s[36:39], s59 offen sc1
    s_waitcnt vmcnt(2)
    ds_read_b64_tr_b16 v[16:17], v7 offset:0
    ds_read_b64_tr_b16 v[18:19], v7 offset:2048
    ds_read_b64_tr_b16 v[20:21], v7 offset:32
    ds_read_b64_tr_b16 v[22:23], v7 offset:2080
    ds_read_b64_tr_b16 v[24:25], v7 offset:64
    ds_read_b64_tr_b16 v[26:27], v7 offset:2112
    ds_read_b64_tr_b16 v[28:29], v7 offset:96
    ds_read_b64_tr_b16 v[30:31], v7 offset:2144
    s_branch L_wo_poll_chk
L_wo_poll:
    buffer_load_dwordx4 v[32:35], v11, s[36:39], s58 offen offset:512 sc1
    buffer_load_dwordx4 v[36:39], v12, s[36:39], s59 offen sc1
L_wo_poll_chk:
    s_waitcnt vmcnt(1)
    v_xor_b32 v32, s68, v32
    v_xor_b32 v33, s45, v33
    v_xor_b32 v34, s46, v34
    v_xor_b32 v35, s47, v35
    v_or_b32 v62, v32, v33
    v_or3_b32 v62, v62, v34, v35
    s_waitcnt vmcnt(0)
    v_xor_b32 v36, s68, v36
    v_xor_b32 v37, s45, v37
    v_xor_b32 v38, s46, v38
    v_xor_b32 v39, s47, v39
    v_or3_b32 v62, v62, v36, v37
    v_or3_b32 v62, v62, v38, v39
    v_cmp_ne_u32_sdwa vcc, v62, v63 src0_sel:BYTE_0 src1_sel:DWORD
    s_and_b64 exec, vcc, vcc
    s_cbranch_scc0 L_wo_poll_ok
    s_add_u32 s60, s60, 1
    s_cmp_lt_u32 s60, 1000000
    s_cbranch_scc1 L_wo_poll
L_wo_poll_ok:
    s_mov_b64 exec, -1
    v_max_f32_dpp v34, v32, v32 row_ror:8 row_mask:0xf bank_mask:0xf
    v_mov_b32 v35, v34
    s_nop 1
    v_permlane16_swap_b32 v35, v34
    v_max_f32 v34, v34, v35
    v_mov_b32 v35, v34
    s_nop 1
    v_permlane32_swap_b32 v35, v34
    v_max_f32 v34, v34, v35
    v_sub_f32 v32, v32, v34
    v_mul_f32 v32, 0x3fb8aa3b, v32
    v_exp_f32 v32, v32
    s_nop 0
    v_mul_f32 v33, v32, v33
    v_mul_f32 v36, v32, v36
    v_mul_f32 v37, v32, v37
    v_mul_f32 v38, v32, v38
    v_mul_f32 v39, v32, v39
    v_add_f32_dpp v33, v33, v33 row_ror:8 row_mask:0xf bank_mask:0xf
    v_add_f32_dpp v44, v36, v36 row_ror:8 row_mask:0xf bank_mask:0x3
    v_add_f32_dpp v45, v37, v37 row_ror:8 row_mask:0xf bank_mask:0x3
    v_mov_b32 v34, v33
    v_add_f32_dpp v44, v38, v38 row_ror:8 row_mask:0xf bank_mask:0xc
    v_add_f32_dpp v45, v39, v39 row_ror:8 row_mask:0xf bank_mask:0xc
    v_permlane16_swap_b32 v34, v33
    s_nop 0
    v_permlane16_swap_b32 v44, v45
    v_add_f32 v33, v33, v34
    v_add_f32 v44, v44, v45
    v_mov_b32 v34, v33
    v_mov_b32 v45, v44
    s_nop 0
    v_permlane32_swap_b32 v34, v33
    v_permlane32_swap_b32 v45, v44
    v_add_f32 v33, v33, v34
    v_add_f32 v44, v44, v45
    v_rcp_f32 v33, v33
    s_nop 0
    v_mul_f32 v44, v44, v33
    s_nop 1
    v_mov_b32_dpp v45, v44 quad_perm:[1,0,3,2] row_mask:0xf bank_mask:0xf
    v_cvt_pk_bf16_f32 v45, v44, v45
    s_nop 1
    v_mov_b32_dpp v48, v45 row_newbcast:0 row_mask:0x3 bank_mask:0xf
    v_mov_b32_dpp v49, v45 row_newbcast:2 row_mask:0x3 bank_mask:0xf
    v_mov_b32_dpp v50, v45 row_newbcast:4 row_mask:0x3 bank_mask:0xf
    v_mov_b32_dpp v51, v45 row_newbcast:6 row_mask:0x3 bank_mask:0xf
    v_mov_b32_dpp v48, v45 row_newbcast:8 row_mask:0xc bank_mask:0xf
    v_mov_b32_dpp v49, v45 row_newbcast:10 row_mask:0xc bank_mask:0xf
    v_mov_b32_dpp v50, v45 row_newbcast:12 row_mask:0xc bank_mask:0xf
    v_mov_b32_dpp v51, v45 row_newbcast:14 row_mask:0xc bank_mask:0xf
    s_waitcnt lgkmcnt(0)
    s_nop 0
    v_mfma_f32_16x16x32_bf16 v[56:59], v[48:51], v[16:19], 0
    v_mfma_f32_16x16x32_bf16 v[64:67], v[48:51], v[20:23], 0
    v_mfma_f32_16x16x32_bf16 v[68:71], v[48:51], v[24:27], 0
    v_mfma_f32_16x16x32_bf16 v[72:75], v[48:51], v[28:31], 0
    s_mov_b32 s54, 0xffff0000
    s_mov_b32 s55, 0xffff0000
    s_mov_b32 s56, 0
    s_mov_b32 s57, -1
    s_nop 1
    v_cndmask_b32 v56, v56, v64, s[54:55]
    s_nop 0
    v_cndmask_b32 v68, v68, v72, s[54:55]
    v_cndmask_b32 v56, v56, v68, s[56:57]
    ds_write_b32 v13, v56 offset:4736
    s_waitcnt lgkmcnt(0)
    s_barrier
    s_branch L_exit

L_T_ffn:
    s_lshl_b32 s52, s3, 6
    v_add_u32 v10, s52, v9
    v_mul_u32_u24 v10, 2752, v10
    v_and_b32 v14, 1, v0
    v_lshl_add_u32 v10, v14, 4, v10
    s_lshl_b32 s52, s62, 5
    v_add_u32 v10, s52, v10
    v_mov_b32 v72, s16
    v_mov_b32 v73, s17
    v_mov_b32 v14, s18
    v_mov_b32 v15, s19
    v_cndmask_b32 v72, v72, v14, s[54:55]
    v_cndmask_b32 v73, v73, v15, s[54:55]
    v_add_co_u32 v72, vcc, v72, v10
    s_nop 1
    v_addc_co_u32 v73, vcc, 0, v73, vcc
    v_and_b32 v14, 15, v0
    v_lshl_add_u32 v14, v14, 2, v3
    v_lshlrev_b32 v14, 1, v14
    s_lshl_b32 s52, s3, 7
    v_add_u32 v14, s52, v14
    s_mov_b32 s40, s4
    s_and_b32 s41, s5, 0xffff
    s_mov_b32 s42, 1024
    s_mov_b32 s43, 0x20000
    buffer_load_ushort v68, v14, s[40:43], 0 offen
    v_lshlrev_b32 v70, 4, v5
    v_mul_u32_u24 v10, 2176, v4
    v_add_u32 v70, v70, v10
    s_lshl_b32 s52, s3, 8
    v_add_u32 v70, s52, v70
    v_mul_u32_u24 v71, 40, v0
    s_lshl_b32 s52, s3, 2
    v_add_u32 v71, s52, v71
    v_bfe_u32 v74, v0, 3, 1
    v_mul_u32_u24 v74, 40, v74
    v_add_u32 v74, s52, v74
    v_mov_b32 v48, 0x3f803f80
    v_mov_b32 v49, 0x3f803f80
    v_mov_b32 v50, 0x3f803f80
    v_mov_b32 v51, 0x3f803f80
    v_mov_b32 v52, 0x3f803f80
    v_mov_b32 v53, 0x3f803f80
    v_mov_b32 v54, 0x3f803f80
    v_mov_b32 v55, 0x3f803f80
    s_barrier
    s_barrier
    s_cmp_eq_u32 s3, 3
    s_cbranch_scc0 L_pf_4
    v_and_b32 v100, 7, v0
    v_lshlrev_b32 v100, 7, v100
    s_lshl_b32 s52, s69, 5
    s_sub_u32 s52, s52, 4
    v_min_u32 v100, s52, v100
    v_lshrrev_b32 v102, 3, v0
    v_mul_u32_u24 v102, 2752, v102
    v_add_u32 v100, v100, v102
    s_sub_u32 s52, s29, 16
    s_mul_i32 s52, s52, 88064
    s_lshl_b32 s53, s67, 5
    s_add_u32 s53, s53, s52
    s_mov_b32 s40, s16
    s_and_b32 s41, s17, 0xffff
    s_mov_b32 s42, 1409024
    s_mov_b32 s43, 0x20000
    s_add_u32 s52, s53, 0
    buffer_load_dword v101, v100, s[40:43], s52 offen
    s_add_u32 s52, s53, 22016
    buffer_load_dword v101, v100, s[40:43], s52 offen
    s_add_u32 s52, s53, 44032
    buffer_load_dword v101, v100, s[40:43], s52 offen
    s_add_u32 s52, s53, 66048
    buffer_load_dword v101, v100, s[40:43], s52 offen
    s_mov_b32 s40, s18
    s_and_b32 s41, s19, 0xffff
    s_mov_b32 s42, 1409024
    s_mov_b32 s43, 0x20000
    s_add_u32 s52, s53, 0
    buffer_load_dword v101, v100, s[40:43], s52 offen
    s_add_u32 s52, s53, 22016
    buffer_load_dword v101, v100, s[40:43], s52 offen
    s_add_u32 s52, s53, 44032
    buffer_load_dword v101, v100, s[40:43], s52 offen
    s_add_u32 s52, s53, 66048
    buffer_load_dword v101, v100, s[40:43], s52 offen
L_pf_4:
    s_cmp_eq_u32 s3, 3
    s_cbranch_scc0 L_ffn_go
    s_waitcnt vmcnt(0)
L_ffn_go:
    s_barrier
    s_add_u32 m0, s61, 0
    s_nop 0
    global_load_lds_dwordx4 v[72:73], off
    v_add_co_u32 v72, vcc, 44032, v72
    s_nop 1
    v_addc_co_u32 v73, vcc, 0, v73, vcc
    s_add_u32 m0, s61, 1024
    s_nop 0
    global_load_lds_dwordx4 v[72:73], off
    v_add_co_u32 v72, vcc, 44032, v72
    s_nop 1
    v_addc_co_u32 v73, vcc, 0, v73, vcc
    s_add_u32 m0, s61, 2048
    s_nop 0
    global_load_lds_dwordx4 v[72:73], off
    v_add_co_u32 v72, vcc, 44032, v72
    s_nop 1
    v_addc_co_u32 v73, vcc, 0, v73, vcc
    s_add_u32 m0, s61, 3072
    s_nop 0
    global_load_lds_dwordx4 v[72:73], off
    s_mov_b32 s58, 0x90000
    s_mov_b32 s59, 0x94400
    s_mov_b32 s60, 0
    v_mov_b32 v63, 0
    buffer_load_dwordx4 v[36:39], v70, s[36:39], s58 offen sc1
    buffer_load_dwordx4 v[40:43], v70, s[36:39], s58 offen offset:128 sc1
    buffer_load_dwordx4 v[80:83], v70, s[36:39], s59 offen sc1
    buffer_load_dwordx4 v[84:87], v70, s[36:39], s59 offen offset:128 sc1
    s_waitcnt vmcnt(4)
    ds_read_b64_tr_b16 v[16:17], v7 offset:0
    ds_read_b64_tr_b16 v[18:19], v7 offset:1024
    ds_read_b64_tr_b16 v[20:21], v7 offset:32
    ds_read_b64_tr_b16 v[22:23], v7 offset:1056
    ds_read_b64_tr_b16 v[24:25], v7 offset:2048
    ds_read_b64_tr_b16 v[26:27], v7 offset:3072
    ds_read_b64_tr_b16 v[28:29], v7 offset:2080
    ds_read_b64_tr_b16 v[30:31], v7 offset:3104
    s_branch L_ffn_poll_chk
L_ffn_poll:
    buffer_load_dwordx4 v[36:39], v70, s[36:39], s58 offen sc1
    buffer_load_dwordx4 v[40:43], v70, s[36:39], s58 offen offset:128 sc1
    buffer_load_dwordx4 v[80:83], v70, s[36:39], s59 offen sc1
    buffer_load_dwordx4 v[84:87], v70, s[36:39], s59 offen offset:128 sc1
L_ffn_poll_chk:
    s_waitcnt vmcnt(3)
    v_xor_b32 v36, s68, v36
    v_xor_b32 v37, s45, v37
    v_xor_b32 v38, s46, v38
    v_xor_b32 v39, s47, v39
    v_or_b32 v62, v36, v37
    v_or3_b32 v62, v62, v38, v39
    s_waitcnt vmcnt(2)
    v_xor_b32 v40, s68, v40
    v_xor_b32 v41, s45, v41
    v_xor_b32 v42, s46, v42
    v_xor_b32 v43, s47, v43
    v_or3_b32 v62, v62, v40, v41
    v_or3_b32 v62, v62, v42, v43
    s_waitcnt vmcnt(1)
    v_xor_b32 v80, s68, v80
    v_xor_b32 v81, s45, v81
    v_xor_b32 v82, s46, v82
    v_xor_b32 v83, s47, v83
    v_or3_b32 v62, v62, v80, v81
    v_or3_b32 v62, v62, v82, v83
    s_waitcnt vmcnt(0)
    v_xor_b32 v84, s68, v84
    v_xor_b32 v85, s45, v85
    v_xor_b32 v86, s46, v86
    v_xor_b32 v87, s47, v87
    v_or3_b32 v62, v62, v84, v85
    v_or3_b32 v62, v62, v86, v87
    v_cmp_ne_u32_sdwa vcc, v62, v63 src0_sel:BYTE_0 src1_sel:DWORD
    s_and_b64 exec, vcc, vcc
    s_cbranch_scc0 L_ffn_poll_ok
    s_add_u32 s60, s60, 1
    s_cmp_lt_u32 s60, 1000000
    s_cbranch_scc1 L_ffn_poll
L_ffn_poll_ok:
    s_mov_b64 exec, -1
    v_lshlrev_b32 v68, 16, v68
    v_pk_add_f32 v[36:37], v[36:37], v[80:81]
    v_pk_add_f32 v[38:39], v[38:39], v[82:83]
    v_pk_add_f32 v[40:41], v[40:41], v[84:85]
    v_pk_add_f32 v[42:43], v[42:43], v[86:87]
    v_add_f32_dpp v44, v36, v36 row_ror:8 row_mask:0xf bank_mask:0x3
    v_add_f32_dpp v45, v37, v37 row_ror:8 row_mask:0xf bank_mask:0x3
    v_add_f32_dpp v46, v38, v38 row_ror:8 row_mask:0xf bank_mask:0x3
    v_add_f32_dpp v47, v39, v39 row_ror:8 row_mask:0xf bank_mask:0x3
    v_add_f32_dpp v44, v40, v40 row_ror:8 row_mask:0xf bank_mask:0xc
    v_add_f32_dpp v45, v41, v41 row_ror:8 row_mask:0xf bank_mask:0xc
    v_add_f32_dpp v46, v42, v42 row_ror:8 row_mask:0xf bank_mask:0xc
    v_add_f32_dpp v47, v43, v43 row_ror:8 row_mask:0xf bank_mask:0xc
    v_permlane16_swap_b32 v44, v45
    s_nop 0
    v_permlane16_swap_b32 v46, v47
    v_add_f32 v44, v44, v45
    v_add_f32 v46, v46, v47
    s_nop 1
    v_permlane32_swap_b32 v44, v46
    v_add_f32 v44, v44, v46
    v_cvt_pk_bf16_f32 v44, v44, v44
    v_and_b32 v44, 0xffff0000, v44
    v_add_f32 v44, v44, v68
    s_nop 1
    v_mov_b32_dpp v45, v44 quad_perm:[1,0,3,2] row_mask:0xf bank_mask:0xf
    v_cvt_pk_bf16_f32 v45, v44, v45
    s_nop 1
    v_mov_b32_dpp v48, v45 row_newbcast:0 row_mask:0xf bank_mask:0x3
    v_mov_b32_dpp v49, v45 row_newbcast:2 row_mask:0xf bank_mask:0x3
    v_mov_b32_dpp v50, v45 row_newbcast:4 row_mask:0xf bank_mask:0x3
    v_mov_b32_dpp v51, v45 row_newbcast:6 row_mask:0xf bank_mask:0x3
    v_mov_b32_dpp v52, v45 row_newbcast:8 row_mask:0xf bank_mask:0x3
    v_mov_b32_dpp v53, v45 row_newbcast:10 row_mask:0xf bank_mask:0x3
    v_mov_b32_dpp v54, v45 row_newbcast:12 row_mask:0xf bank_mask:0x3
    v_mov_b32_dpp v55, v45 row_newbcast:14 row_mask:0xf bank_mask:0x3
    s_waitcnt lgkmcnt(0)
    v_mfma_f32_16x16x32_bf16 v[56:59], v[48:51], v[16:19], 0
    v_mfma_f32_16x16x32_bf16 v[64:67], v[48:51], v[20:23], 0
    v_mfma_f32_16x16x32_bf16 v[76:79], v[48:51], v[48:51], 0
    v_mfma_f32_16x16x32_bf16 v[56:59], v[52:55], v[24:27], v[56:59]
    v_mfma_f32_16x16x32_bf16 v[64:67], v[52:55], v[28:31], v[64:67]
    v_mfma_f32_16x16x32_bf16 v[76:79], v[52:55], v[52:55], v[76:79]
    s_mov_b32 s54, 0xffff0000
    s_mov_b32 s55, 0xffff0000
    s_nop 4
    v_cndmask_b32 v56, v56, v64, s[54:55]
    ds_write_b32 v71, v56 offset:4736
    s_mov_b32 exec_lo, 0x101
    s_mov_b32 exec_hi, 0x0
    ds_write_b32 v74, v76 offset:7296
    s_waitcnt lgkmcnt(0)
    s_barrier
    s_branch L_exit

L_T_fin:
    s_lshr_b32 s53, s28, 1
    s_lshl_b32 s53, s53, 3
    s_add_u32 s52, s52, s53
    s_lshl_b32 s52, s52, 1
    s_add_u32 s64, s52, s3
    v_and_b32 v4, 1, v0
    v_lshlrev_b32 v5, 3, v4
    s_lshl_b32 s52, s64, 4
    v_add_u32 v5, s52, v5
    s_mov_b32 s40, s4
    s_and_b32 s41, s5, 0xffff
    s_mov_b32 s42, 1024
    s_mov_b32 s43, 0x20000
    buffer_load_dwordx2 v[8:9], v5, s[40:43], 0 offen
    v_lshlrev_b32 v6, 1, v5
    v_bfe_u32 v7, v0, 1, 3
    v_mul_u32_u24 v7, 2176, v7
    v_add_u32 v10, v7, v6
    v_lshrrev_b32 v7, 1, v0
    v_mul_u32_u24 v7, 2176, v7
    v_add_u32 v11, v7, v6
    v_lshl_add_u32 v5, v3, 1, v5
    v_mov_b32 v44, 0
    v_mov_b32 v45, 0
    v_mov_b32 v46, 0
    v_mov_b32 v47, 0
    s_barrier
    s_barrier
    s_mov_b32 s58, 0x90000
    s_mov_b32 s59, 0x94400
    s_waitcnt vmcnt(0)
    v_and_b32 v17, 0xffff0000, v8
    v_lshlrev_b32 v16, 16, v8
    v_and_b32 v19, 0xffff0000, v9
    v_lshlrev_b32 v18, 16, v9
    s_mov_b32 s40, s22
    s_and_b32 s41, s23, 0xffff
    s_mov_b32 s42, 1024
    s_mov_b32 s43, 0x20000
    s_mov_b32 s60, 0
    v_mov_b32 v63, 0
L_fin_poll1:
    buffer_load_dwordx4 v[20:23], v10, s[36:39], s58 offen sc1
    buffer_load_dwordx4 v[24:27], v10, s[36:39], s59 offen sc1
    s_waitcnt vmcnt(1)
    v_xor_b32 v20, s68, v20
    v_xor_b32 v21, s45, v21
    v_xor_b32 v22, s46, v22
    v_xor_b32 v23, s47, v23
    v_or_b32 v62, v20, v21
    v_or3_b32 v62, v62, v22, v23
    s_waitcnt vmcnt(0)
    v_xor_b32 v24, s68, v24
    v_xor_b32 v25, s45, v25
    v_xor_b32 v26, s46, v26
    v_xor_b32 v27, s47, v27
    v_or3_b32 v62, v62, v24, v25
    v_or3_b32 v62, v62, v26, v27
    v_cmp_ne_u32_sdwa vcc, v62, v63 src0_sel:BYTE_0 src1_sel:DWORD
    s_and_b64 exec, vcc, vcc
    s_cbranch_scc0 L_fin_poll1_ok
    s_add_u32 s60, s60, 1
    s_cmp_lt_u32 s60, 1000000
    s_sleep 2
    s_cbranch_scc1 L_fin_poll1
L_fin_poll1_ok:
    s_mov_b64 exec, -1
    v_add_f32 v20, v20, v24
    v_add_f32 v21, v21, v25
    v_add_f32 v22, v22, v26
    v_add_f32 v23, v23, v27
    v_add_f32_dpp v20, v20, v20 quad_perm:[2,3,0,1] row_mask:0xf bank_mask:0xf
    v_add_f32_dpp v21, v21, v21 quad_perm:[2,3,0,1] row_mask:0xf bank_mask:0xf
    v_add_f32_dpp v22, v22, v22 quad_perm:[2,3,0,1] row_mask:0xf bank_mask:0xf
    v_add_f32_dpp v23, v23, v23 quad_perm:[2,3,0,1] row_mask:0xf bank_mask:0xf
    v_add_f32_dpp v20, v20, v20 row_ror:4 row_mask:0xf bank_mask:0xf
    v_add_f32_dpp v21, v21, v21 row_ror:4 row_mask:0xf bank_mask:0xf
    v_add_f32_dpp v22, v22, v22 row_ror:4 row_mask:0xf bank_mask:0xf
    v_add_f32_dpp v23, v23, v23 row_ror:4 row_mask:0xf bank_mask:0xf
    v_add_f32_dpp v20, v20, v20 row_ror:8 row_mask:0xf bank_mask:0xf
    v_add_f32_dpp v21, v21, v21 row_ror:8 row_mask:0xf bank_mask:0xf
    v_add_f32_dpp v22, v22, v22 row_ror:8 row_mask:0xf bank_mask:0xf
    v_add_f32_dpp v23, v23, v23 row_ror:8 row_mask:0xf bank_mask:0xf
    v_cvt_pk_bf16_f32 v24, v20, v21
    v_cvt_pk_bf16_f32 v25, v22, v23
    v_and_b32 v21, 0xffff0000, v24
    v_lshlrev_b32 v20, 16, v24
    v_and_b32 v23, 0xffff0000, v25
    v_lshlrev_b32 v22, 16, v25
    v_add_f32 v20, v20, v16
    v_add_f32 v21, v21, v17
    v_add_f32 v22, v22, v18
    v_add_f32 v23, v23, v19
    v_cmp_eq_u32 vcc, 1, v3
    s_nop 1
    v_cndmask_b32 v20, v20, v21, vcc
    v_cmp_eq_u32 vcc, 2, v3
    s_nop 1
    v_cndmask_b32 v20, v20, v22, vcc
    v_cmp_eq_u32 vcc, 3, v3
    s_nop 1
    v_cndmask_b32 v20, v20, v23, vcc
    v_cvt_pk_bf16_f32 v20, v20, v20
    v_and_b32 v20, 0xffff0000, v20
    s_mov_b32 s58, 0xa0000
    s_mov_b32 s59, 0xb1000
    s_mov_b32 s53, 0xc2000
    v_mov_b32 v63, 0
    s_mov_b32 s60, 0
    s_mov_b32 s54, -1
    s_mov_b32 s55, 0xfff
    s_sleep 44
L_fin_poll2:
    buffer_load_dwordx4 v[36:39], v11, s[36:39], s58 offen sc1
    buffer_load_dwordx4 v[40:43], v11, s[36:39], s59 offen sc1
    s_mov_b64 s[56:57], exec
    s_and_b64 exec, exec, s[54:55]
    s_cbranch_scc0 L_fin_no3
    buffer_load_dwordx4 v[44:47], v11, s[36:39], s53 offen sc1
L_fin_no3:
    s_waitcnt vmcnt(0)
    s_mov_b64 exec, s[56:57]
    v_xor_b32 v36, s68, v36
    v_xor_b32 v37, s45, v37
    v_xor_b32 v38, s46, v38
    v_xor_b32 v39, s47, v39
    v_or_b32 v62, v36, v37
    v_or3_b32 v62, v62, v38, v39
    v_xor_b32 v40, s68, v40
    v_xor_b32 v41, s45, v41
    v_xor_b32 v42, s46, v42
    v_xor_b32 v43, s47, v43
    v_or3_b32 v62, v62, v40, v41
    v_or3_b32 v62, v62, v42, v43
    s_and_b64 exec, exec, s[54:55]
    v_xor_b32 v44, s68, v44
    v_xor_b32 v45, s45, v45
    v_xor_b32 v46, s46, v46
    v_xor_b32 v47, s47, v47
    v_or3_b32 v62, v62, v44, v45
    v_or3_b32 v62, v62, v46, v47
    s_mov_b64 exec, s[56:57]
    v_cmp_ne_u32_sdwa vcc, v62, v63 src0_sel:BYTE_0 src1_sel:DWORD
    s_and_b64 exec, vcc, vcc
    s_cbranch_scc0 L_fin_got2
    s_add_u32 s60, s60, 1
    s_cmp_lt_u32 s60, 1000000
    s_cbranch_scc1 L_fin_poll2
L_fin_got2:
    s_mov_b64 exec, -1
    v_add_f32 v36, v36, v40
    v_add_f32 v37, v37, v41
    v_add_f32 v38, v38, v42
    v_add_f32 v39, v39, v43
    v_add_f32 v36, v36, v44
    v_add_f32 v37, v37, v45
    v_add_f32 v38, v38, v46
    v_add_f32 v39, v39, v47
    v_add_f32_dpp v36, v36, v36 quad_perm:[2,3,0,1] row_mask:0xf bank_mask:0xf
    v_add_f32_dpp v37, v37, v37 quad_perm:[2,3,0,1] row_mask:0xf bank_mask:0xf
    v_add_f32_dpp v38, v38, v38 quad_perm:[2,3,0,1] row_mask:0xf bank_mask:0xf
    v_add_f32_dpp v39, v39, v39 quad_perm:[2,3,0,1] row_mask:0xf bank_mask:0xf
    v_add_f32_dpp v36, v36, v36 row_ror:4 row_mask:0xf bank_mask:0xf
    v_add_f32_dpp v37, v37, v37 row_ror:4 row_mask:0xf bank_mask:0xf
    v_add_f32_dpp v38, v38, v38 row_ror:4 row_mask:0xf bank_mask:0xf
    v_add_f32_dpp v39, v39, v39 row_ror:4 row_mask:0xf bank_mask:0xf
    v_add_f32_dpp v36, v36, v36 row_ror:8 row_mask:0xf bank_mask:0xf
    v_add_f32_dpp v37, v37, v37 row_ror:8 row_mask:0xf bank_mask:0xf
    v_add_f32_dpp v38, v38, v38 row_ror:8 row_mask:0xf bank_mask:0xf
    v_add_f32_dpp v39, v39, v39 row_ror:8 row_mask:0xf bank_mask:0xf
    v_permlane16_swap_b32 v36, v37
    s_nop 0
    v_permlane16_swap_b32 v38, v39
    v_add_f32 v36, v36, v37
    v_add_f32 v38, v38, v39
    s_nop 1
    v_permlane32_swap_b32 v36, v38
    v_add_f32 v36, v36, v38
    v_cvt_pk_bf16_f32 v36, v36, v36
    v_and_b32 v36, 0xffff0000, v36
    v_add_f32 v36, v36, v20
    v_cvt_pk_bf16_f32 v36, v36, v36
    s_mov_b32 exec_lo, 0x30003
    s_mov_b32 exec_hi, 0x30003
    buffer_store_short v36, v5, s[40:43], 0 offen
    s_cmp_lg_u32 s64, 0
    s_cbranch_scc1 L_fin_done
    s_mov_b64 exec, 1
    v_mov_b32 v4, s44
    v_mov_b32 v6, 0
    buffer_store_dword v4, v6, s[36:39], 0 offen
L_fin_done:
L_exit:
L_end:
    s_endpgm
    .fill 32, 4, 0xbf800000
.section .rodata,"a"
.p2align 6
.amdhsa_kernel sequential_preLN__mha_block_cached__geglu_ffn__decode_kernel
  .amdhsa_next_free_vgpr 168
  .amdhsa_next_free_sgpr 72
  .amdhsa_accum_offset 168
  .amdhsa_group_segment_fixed_size 0
  .amdhsa_kernarg_size 96
  .amdhsa_user_sgpr_count 2
  .amdhsa_user_sgpr_kernarg_segment_ptr 1
  .amdhsa_system_sgpr_workgroup_id_x 1
  .amdhsa_float_denorm_mode_32 3
.end_amdhsa_kernel
```
